```python
import torch

def _softmax(x, axis=-1):
    return torch.softmax(x, dim=axis)
def _gelu(x):
    return torch.nn.functional.gelu(x, approximate="tanh")
def _silu(x):
    return torch.nn.functional.silu(x)
def _sigmoid(x):
    return torch.sigmoid(x)
def _layernorm(x, axis=-1, eps=1e-5):
    m = x.mean(dim=axis, keepdim=True)
    v = x.var(dim=axis, keepdim=True, unbiased=False)
    return (x - m) / torch.sqrt(v + eps)
def _scatter_add(tgt, idx, src, axis=0):
    return tgt.clone().index_add_(axis, idx, src)
def _segment_sum(src, seg, n):
    out = torch.zeros((n,) + src.shape[1:], dtype=src.dtype)
    return out.index_add_(0, seg, src)
def _pad(x, pw):
    flat = tuple(v for pair in reversed(pw) for v in pair)
    return torch.nn.functional.pad(x, flat)

kernel_name = 'recurrent_scan__mha_block__geglu_ffn__prompt'

def setup_inputs():

    _w = (lambda a: (lambda t: t.to(torch.bfloat16) if t.is_floating_point() else t)(torch.as_tensor(a)))
    def _A_setup():
        B, S, D, H = 1, 2048, 448, 16
        return {
            "x": _w((lambda *s: torch.randn(*s, dtype=torch.bfloat16) * 0.05)(B, S, D)),
            "wqkv": _w((lambda *s: torch.randn(*s, dtype=torch.bfloat16) * 0.05)(D, 3 * D)),
            "wo": _w((lambda *s: torch.randn(*s, dtype=torch.bfloat16) * 0.05)(D, D)),
        }
    _A_in = _A_setup()

    def _B_setup():
        B, S, D, F = 1, 2048, 448, 1792
        return {
            "x": _w((lambda *s: torch.randn(*s, dtype=torch.bfloat16) * 0.05)(B, S, D)),
            "w_gate": _w((lambda *s: torch.randn(*s, dtype=torch.bfloat16) * 0.05)(D, F)),
            "w_up": _w((lambda *s: torch.randn(*s, dtype=torch.bfloat16) * 0.05)(D, F)),
            "w_down": _w((lambda *s: torch.randn(*s, dtype=torch.bfloat16) * 0.05)(F, D)),
        }
    _B_in = _B_setup()

    return {
        "A_x": _A_in["x"],
        "A_wqkv": _A_in["wqkv"],
        "A_wo": _A_in["wo"],
        "B_x": _B_in["x"],
        "B_w_gate": _B_in["w_gate"],
        "B_w_up": _B_in["w_up"],
        "B_w_down": _B_in["w_down"],
    }

def reference(A_x, A_wqkv, A_wo, B_x, B_w_gate, B_w_up, B_w_down):
    def _A_ref(x, wqkv, wo):
        B, S, D = x.shape
        H = 16
        Dh = D // H
        qkv = (lambda x, *d: x.permute(*d))((x @ wqkv).reshape(B, S, 3, H, Dh), 2, 0, 3, 1, 4)
        q, k, v = qkv[0], qkv[1], qkv[2]
        scores = torch.einsum("bhqd,bhkd->bhqk", q, k) * (Dh ** -0.5)
        p = _softmax(scores, axis=-1)
        o = torch.einsum("bhqk,bhkd->bhqd", p, v)
        return (lambda x, *d: x.permute(*d))(o, 0, 2, 1, 3).reshape(B, S, D) @ wo

    def _B_ref(x, w_gate, w_up, w_down):
        return (_gelu(x @ w_gate) * (x @ w_up)) @ w_down

    x = A_x
    xn = _layernorm(x, axis=-1)
    s = _A_ref(xn, A_wqkv, A_wo)
    g = _silu(_B_ref(xn, B_w_gate, B_w_up, B_w_down))
    return x + s * g
```

```asm
; @launch grid=(256,1,1) block=(768,1,1) lds=163840
.amdgcn_target "amdgcn-amd-amdhsa--gfx950"
.text
.globl recurrent_scan__mha_block__geglu_ffn__prompt_kernel
.p2align 8
.type recurrent_scan__mha_block__geglu_ffn__prompt_kernel,@function
recurrent_scan__mha_block__geglu_ffn__prompt_kernel:
  s_cmp_ge_u32 s2, 256
  s_cbranch_scc1 L_exit
  s_load_dwordx16 s[16:31], s[0:1], 0
  s_load_dwordx4 s[32:35], s[0:1], 64
  v_lshrrev_b32 v2, 6, v0
  v_and_b32 v0, 63, v0
  v_readfirstlane_b32 s59, v2
  s_and_b32 s5, s2, 7
  s_lshr_b32 s6, s2, 3
  s_and_b32 s7, s5, 3
  s_lshl_b32 s7, s7, 2
  s_and_b32 s8, s6, 3
  s_add_u32 s62, s7, s8
  s_lshr_b32 s7, s5, 2
  s_lshl_b32 s7, s7, 3
  s_lshr_b32 s8, s6, 2
  s_add_u32 s7, s7, s8
  s_and_b32 s8, s7, 1
  s_lshr_b32 s7, s7, 1
  s_cmp_ge_u32 s59, 8
  s_cbranch_scc1 L_service
  s_and_b32 s60, s59, 3
  s_lshr_b32 s61, s59, 2
  s_xor_b32 s61, s61, s8
  v_lshrrev_b32 v12, 2, v0
  v_lshrrev_b32 v13, 4, v0
  v_xor_b32 v13, v13, v0
  v_and_b32 v13, 3, v13
  v_mul_u32_u24 v12, 896, v12
  v_lshl_add_u32 v12, v13, 4, v12
  s_lshl_b32 s9, s62, 2
  s_add_u32 s63, s9, s60
  s_mul_i32 s9, s63, 28672
  s_mul_i32 s10, s61, 448
  s_add_u32 s9, s9, s10
  v_add_u32 v12, s9, v12
  s_mul_i32 s10, s59, 14336
  s_mov_b32 s11, 14336
  s_waitcnt lgkmcnt(0)
  s_mov_b32 s44, s32
  s_mov_b32 s45, s33
  s_mov_b32 s46, 256
  s_mov_b32 s47, 0x20000
  s_add_u32 s12, s2, s59
  s_cmp_lg_u32 s12, 0
  s_cbranch_scc1 L_notagw
  s_memrealtime s[12:13]
  s_waitcnt lgkmcnt(0)
  s_or_b32 s12, s12, 1
  v_mov_b32 v16, s12
  v_mov_b32 v17, s13
  s_mov_b64 exec, 1
  buffer_store_dwordx2 v[16:17], off, s[44:47], 0 sc1
  s_mov_b64 exec, -1
L_notagw:
  s_mov_b32 s36, s16
  s_mov_b32 s37, s17
  s_mov_b32 s38, 1835008
  s_mov_b32 s39, 0x20000
  s_add_u32 m0, s10, 0
  s_nop 0
  buffer_load_dwordx4 v12, s[36:39], 0 offen offset:0 lds
  s_add_u32 m0, s10, 7168
  s_nop 0
  buffer_load_dwordx4 v12, s[36:39], s11 offen offset:0 lds
  s_add_u32 m0, s10, 960
  s_nop 0
  buffer_load_dwordx4 v12, s[36:39], 0 offen offset:64 lds
  s_add_u32 m0, s10, 8128
  s_nop 0
  buffer_load_dwordx4 v12, s[36:39], s11 offen offset:64 lds
  s_add_u32 m0, s10, 1920
  s_nop 0
  buffer_load_dwordx4 v12, s[36:39], 0 offen offset:128 lds
  s_add_u32 m0, s10, 9088
  s_nop 0
  buffer_load_dwordx4 v12, s[36:39], s11 offen offset:128 lds
  s_add_u32 m0, s10, 2880
  s_nop 0
  buffer_load_dwordx4 v12, s[36:39], 0 offen offset:192 lds
  s_add_u32 m0, s10, 10048
  s_nop 0
  buffer_load_dwordx4 v12, s[36:39], s11 offen offset:192 lds
  s_add_u32 m0, s10, 3840
  s_nop 0
  buffer_load_dwordx4 v12, s[36:39], 0 offen offset:256 lds
  s_add_u32 m0, s10, 11008
  s_nop 0
  buffer_load_dwordx4 v12, s[36:39], s11 offen offset:256 lds
  s_add_u32 m0, s10, 4800
  s_nop 0
  buffer_load_dwordx4 v12, s[36:39], 0 offen offset:320 lds
  s_add_u32 m0, s10, 11968
  s_nop 0
  buffer_load_dwordx4 v12, s[36:39], s11 offen offset:320 lds
  s_add_u32 m0, s10, 5760
  s_nop 0
  buffer_load_dwordx4 v12, s[36:39], 0 offen offset:384 lds
  s_add_u32 m0, s10, 12928
  s_nop 0
  buffer_load_dwordx4 v12, s[36:39], s11 offen offset:384 lds
  s_mov_b32 s40, s34
  s_mov_b32 s41, s35
  s_mov_b32 s42, 18874368
  s_mov_b32 s43, 0x20000
  v_lshrrev_b32 v13, 5, v0
  v_lshlrev_b32 v13, 10, v13
  v_bfe_u32 v14, v0, 2, 2
  v_lshl_add_u32 v13, v14, 6, v13
  v_bfe_u32 v14, v0, 4, 1
  v_lshl_add_u32 v13, v14, 5, v13
  v_and_b32 v14, 3, v0
  v_lshl_add_u32 v13, v14, 3, v13
  s_lshl_b32 s12, s61, 9
  v_add_u32 v3, s12, v13
  v_add_u32 v1, 114688, v3
  v_add_u32 v2, 131072, v3
  v_bfe_u32 v13, v0, 4, 1
  v_mul_u32_u24 v13, 7168, v13
  v_and_b32 v14, 15, v0
  v_lshl_add_u32 v13, v14, 6, v13
  v_lshrrev_b32 v14, 5, v0
  v_bfe_u32 v15, v0, 2, 2
  v_xor_b32 v14, v14, v15
  v_lshl_add_u32 v160, v14, 4, v13
  v_xor_b32 v14, 2, v14
  v_lshl_add_u32 v161, v14, 4, v13
  v_add_u32 v160, s10, v160
  v_add_u32 v161, s10, v161
  v_mov_b32 v162, 0
  v_mov_b32 v163, 0
  v_mov_b32 v166, 0x3f803f80
  s_mov_b32 s66, 0xffff0000
  s_mov_b32 s64, 0xbeeff558
  s_mov_b32 s65, 0x409d30fc
  v_and_b32 v118, 31, v0
  v_lshlrev_b32 v118, 3, v118
  s_lshl_b32 s12, s59, 8
  s_add_u32 s12, s12, 159744
  v_add_u32 v119, s12, v118
  v_xor_b32 v118, 1024, v119
  s_xor_b32 s12, s59, 4
  s_mul_i32 s12, s12, 14336
  s_sub_u32 s58, s12, s10
  v_lshlrev_b32 v0, 4, v0
  s_lshl_b32 s13, s7, 1
  s_add_u32 s13, s13, s61
  s_cmp_eq_u32 s8, 1
  s_cselect_b32 s69, 0x3e8b97f6, 1.0
  s_cselect_b32 s4, 17, 18
  s_cselect_b32 s15, 0, 2097152
  s_cselect_b32 s14, 0, 4
  s_lshl_b32 s67, s13, s4
  s_sub_u32 s4, s4, 6
  s_lshl_b32 s4, s63, s4
  s_add_u32 s67, s67, s4
  s_add_u32 s67, s67, s15
  s_add_u32 s72, s67, 2048
  s_mul_i32 s12, s7, 6
  s_add_u32 s14, s14, s12
  s_add_u32 s14, s14, s61
  s_lshl_b32 s70, s14, 11
  s_mul_i32 s4, s63, 114688
  s_add_u32 s4, s4, 6291456
  s_add_u32 s70, s70, s4
  s_lshl_b32 s71, s7, 1
  s_add_u32 s71, s71, s61
  s_lshl_b32 s71, s71, 10
  s_add_u32 s71, s71, 98304
  s_add_u32 s71, s71, s4
  s_lshl_b32 s73, s62, 12
  s_lshl_b32 s4, s7, 9
  s_add_u32 s73, s73, s4
  s_xor_b32 s4, s8, 1
  s_lshl_b32 s4, s4, 7
  s_add_u32 s73, s73, s4
  s_add_u32 s73, s73, 17891584
  s_cmp_eq_u32 s61, 1
  s_cselect_b32 s52, -1, 0
  s_mov_b32 s53, 0
  s_mov_b32 s54, 0
  s_cselect_b32 s55, 0, -1
  s_cselect_b32 s56, 15, 0xf0000000
  s_mov_b32 s57, s56
  s_cselect_b32 s48, 1, 0x10000000
  s_mov_b32 s49, s48
  s_cmp_eq_u32 s61, 1
  s_cbranch_scc1 L_half1
  s_waitcnt vmcnt(12)
  ds_read_b128 v[4:7], v160 offset:0
  ds_read_b128 v[8:11], v161 offset:0
  s_waitcnt vmcnt(10)
  ds_read_b128 v[12:15], v160 offset:1024
  ds_read_b128 v[16:19], v161 offset:1024
  s_waitcnt lgkmcnt(2)
  v_dot2c_f32_bf16 v162, v4, v166
  v_dot2c_f32_bf16 v163, v4, v4
  v_dot2c_f32_bf16 v162, v5, v166
  v_dot2c_f32_bf16 v163, v5, v5
  v_dot2c_f32_bf16 v162, v6, v166
  v_dot2c_f32_bf16 v163, v6, v6
  v_dot2c_f32_bf16 v162, v7, v166
  v_dot2c_f32_bf16 v163, v7, v7
  v_dot2c_f32_bf16 v162, v8, v166
  v_dot2c_f32_bf16 v163, v8, v8
  v_dot2c_f32_bf16 v162, v9, v166
  v_dot2c_f32_bf16 v163, v9, v9
  v_dot2c_f32_bf16 v162, v10, v166
  v_dot2c_f32_bf16 v163, v10, v10
  v_dot2c_f32_bf16 v162, v11, v166
  v_dot2c_f32_bf16 v163, v11, v11
  s_waitcnt vmcnt(8)
  ds_read_b128 v[20:23], v160 offset:2048
  ds_read_b128 v[24:27], v161 offset:2048
  s_waitcnt lgkmcnt(2)
  v_dot2c_f32_bf16 v162, v12, v166
  v_dot2c_f32_bf16 v163, v12, v12
  v_dot2c_f32_bf16 v162, v13, v166
  v_dot2c_f32_bf16 v163, v13, v13
  v_dot2c_f32_bf16 v162, v14, v166
  v_dot2c_f32_bf16 v163, v14, v14
  v_dot2c_f32_bf16 v162, v15, v166
  v_dot2c_f32_bf16 v163, v15, v15
  v_dot2c_f32_bf16 v162, v16, v166
  v_dot2c_f32_bf16 v163, v16, v16
  v_dot2c_f32_bf16 v162, v17, v166
  v_dot2c_f32_bf16 v163, v17, v17
  v_dot2c_f32_bf16 v162, v18, v166
  v_dot2c_f32_bf16 v163, v18, v18
  v_dot2c_f32_bf16 v162, v19, v166
  v_dot2c_f32_bf16 v163, v19, v19
  s_waitcnt vmcnt(6)
  ds_read_b128 v[28:31], v160 offset:3072
  ds_read_b128 v[32:35], v161 offset:3072
  s_waitcnt lgkmcnt(2)
  v_dot2c_f32_bf16 v162, v20, v166
  v_dot2c_f32_bf16 v163, v20, v20
  v_dot2c_f32_bf16 v162, v21, v166
  v_dot2c_f32_bf16 v163, v21, v21
  v_dot2c_f32_bf16 v162, v22, v166
  v_dot2c_f32_bf16 v163, v22, v22
  v_dot2c_f32_bf16 v162, v23, v166
  v_dot2c_f32_bf16 v163, v23, v23
  v_dot2c_f32_bf16 v162, v24, v166
  v_dot2c_f32_bf16 v163, v24, v24
  v_dot2c_f32_bf16 v162, v25, v166
  v_dot2c_f32_bf16 v163, v25, v25
  v_dot2c_f32_bf16 v162, v26, v166
  v_dot2c_f32_bf16 v163, v26, v26
  v_dot2c_f32_bf16 v162, v27, v166
  v_dot2c_f32_bf16 v163, v27, v27
  s_waitcnt vmcnt(4)
  ds_read_b128 v[36:39], v160 offset:4096
  ds_read_b128 v[40:43], v161 offset:4096
  s_waitcnt lgkmcnt(2)
  v_dot2c_f32_bf16 v162, v28, v166
  v_dot2c_f32_bf16 v163, v28, v28
  v_dot2c_f32_bf16 v162, v29, v166
  v_dot2c_f32_bf16 v163, v29, v29
  v_dot2c_f32_bf16 v162, v30, v166
  v_dot2c_f32_bf16 v163, v30, v30
  v_dot2c_f32_bf16 v162, v31, v166
  v_dot2c_f32_bf16 v163, v31, v31
  v_dot2c_f32_bf16 v162, v32, v166
  v_dot2c_f32_bf16 v163, v32, v32
  v_dot2c_f32_bf16 v162, v33, v166
  v_dot2c_f32_bf16 v163, v33, v33
  v_dot2c_f32_bf16 v162, v34, v166
  v_dot2c_f32_bf16 v163, v34, v34
  v_dot2c_f32_bf16 v162, v35, v166
  v_dot2c_f32_bf16 v163, v35, v35
  s_waitcnt vmcnt(2)
  ds_read_b128 v[44:47], v160 offset:5120
  ds_read_b128 v[48:51], v161 offset:5120
  s_waitcnt lgkmcnt(2)
  v_dot2c_f32_bf16 v162, v36, v166
  v_dot2c_f32_bf16 v163, v36, v36
  v_dot2c_f32_bf16 v162, v37, v166
  v_dot2c_f32_bf16 v163, v37, v37
  v_dot2c_f32_bf16 v162, v38, v166
  v_dot2c_f32_bf16 v163, v38, v38
  v_dot2c_f32_bf16 v162, v39, v166
  v_dot2c_f32_bf16 v163, v39, v39
  v_dot2c_f32_bf16 v162, v40, v166
  v_dot2c_f32_bf16 v163, v40, v40
  v_dot2c_f32_bf16 v162, v41, v166
  v_dot2c_f32_bf16 v163, v41, v41
  v_dot2c_f32_bf16 v162, v42, v166
  v_dot2c_f32_bf16 v163, v42, v42
  v_dot2c_f32_bf16 v162, v43, v166
  v_dot2c_f32_bf16 v163, v43, v43
  s_waitcnt vmcnt(0)
  ds_read_b128 v[52:55], v160 offset:6144
  ds_read_b128 v[56:59], v161 offset:6144
  s_waitcnt lgkmcnt(2)
  v_dot2c_f32_bf16 v162, v44, v166
  v_dot2c_f32_bf16 v163, v44, v44
  v_dot2c_f32_bf16 v162, v45, v166
  v_dot2c_f32_bf16 v163, v45, v45
  v_dot2c_f32_bf16 v162, v46, v166
  v_dot2c_f32_bf16 v163, v46, v46
  v_dot2c_f32_bf16 v162, v47, v166
  v_dot2c_f32_bf16 v163, v47, v47
  v_dot2c_f32_bf16 v162, v48, v166
  v_dot2c_f32_bf16 v163, v48, v48
  v_dot2c_f32_bf16 v162, v49, v166
  v_dot2c_f32_bf16 v163, v49, v49
  v_dot2c_f32_bf16 v162, v50, v166
  v_dot2c_f32_bf16 v163, v50, v50
  v_dot2c_f32_bf16 v162, v51, v166
  v_dot2c_f32_bf16 v163, v51, v51
  s_waitcnt lgkmcnt(0)
  v_dot2c_f32_bf16 v162, v52, v166
  v_dot2c_f32_bf16 v163, v52, v52
  v_dot2c_f32_bf16 v162, v53, v166
  v_dot2c_f32_bf16 v163, v53, v53
  v_dot2c_f32_bf16 v162, v54, v166
  v_dot2c_f32_bf16 v163, v54, v54
  v_dot2c_f32_bf16 v162, v55, v166
  v_dot2c_f32_bf16 v163, v55, v55
  v_dot2c_f32_bf16 v162, v56, v166
  v_dot2c_f32_bf16 v163, v56, v56
  v_dot2c_f32_bf16 v162, v57, v166
  v_dot2c_f32_bf16 v163, v57, v57
  v_dot2c_f32_bf16 v162, v58, v166
  v_dot2c_f32_bf16 v163, v58, v58
  v_dot2c_f32_bf16 v162, v59, v166
  v_dot2c_f32_bf16 v163, v59, v59
  s_nop 1
  v_mov_b32 v116, v162
  v_mov_b32 v117, v163
  s_nop 0
  v_permlane32_swap_b32 v162, v116
  v_permlane32_swap_b32 v163, v117
  v_add_f32 v162, v162, v116
  v_add_f32 v163, v163, v117
  ds_write_b64 v119, v[162:163]
  v_add_u32 v160, s58, v160
  v_add_u32 v161, s58, v161
  s_waitcnt lgkmcnt(0)
  s_barrier
  ds_read_b64 v[116:117], v118
  ds_read_b128 v[60:63], v160 offset:0
  ds_read_b128 v[64:67], v161 offset:0
  ds_read_b128 v[68:71], v160 offset:1024
  ds_read_b128 v[72:75], v161 offset:1024
  ds_read_b128 v[76:79], v160 offset:2048
  ds_read_b128 v[80:83], v161 offset:2048
  ds_read_b128 v[84:87], v160 offset:3072
  ds_read_b128 v[88:91], v161 offset:3072
  ds_read_b128 v[92:95], v160 offset:4096
  ds_read_b128 v[96:99], v161 offset:4096
  ds_read_b128 v[100:103], v160 offset:5120
  ds_read_b128 v[104:107], v161 offset:5120
  ds_read_b128 v[108:111], v160 offset:6144
  ds_read_b128 v[112:115], v161 offset:6144
  s_branch L_halfj
L_half1:
  s_waitcnt vmcnt(12)
  ds_read_b128 v[60:63], v160 offset:0
  ds_read_b128 v[64:67], v161 offset:0
  s_waitcnt vmcnt(10)
  ds_read_b128 v[68:71], v160 offset:1024
  ds_read_b128 v[72:75], v161 offset:1024
  s_waitcnt lgkmcnt(2)
  v_dot2c_f32_bf16 v162, v60, v166
  v_dot2c_f32_bf16 v163, v60, v60
  v_dot2c_f32_bf16 v162, v61, v166
  v_dot2c_f32_bf16 v163, v61, v61
  v_dot2c_f32_bf16 v162, v62, v166
  v_dot2c_f32_bf16 v163, v62, v62
  v_dot2c_f32_bf16 v162, v63, v166
  v_dot2c_f32_bf16 v163, v63, v63
  v_dot2c_f32_bf16 v162, v64, v166
  v_dot2c_f32_bf16 v163, v64, v64
  v_dot2c_f32_bf16 v162, v65, v166
  v_dot2c_f32_bf16 v163, v65, v65
  v_dot2c_f32_bf16 v162, v66, v166
  v_dot2c_f32_bf16 v163, v66, v66
  v_dot2c_f32_bf16 v162, v67, v166
  v_dot2c_f32_bf16 v163, v67, v67
  s_waitcnt vmcnt(8)
  ds_read_b128 v[76:79], v160 offset:2048
  ds_read_b128 v[80:83], v161 offset:2048
  s_waitcnt lgkmcnt(2)
  v_dot2c_f32_bf16 v162, v68, v166
  v_dot2c_f32_bf16 v163, v68, v68
  v_dot2c_f32_bf16 v162, v69, v166
  v_dot2c_f32_bf16 v163, v69, v69
  v_dot2c_f32_bf16 v162, v70, v166
  v_dot2c_f32_bf16 v163, v70, v70
  v_dot2c_f32_bf16 v162, v71, v166
  v_dot2c_f32_bf16 v163, v71, v71
  v_dot2c_f32_bf16 v162, v72, v166
  v_dot2c_f32_bf16 v163, v72, v72
  v_dot2c_f32_bf16 v162, v73, v166
  v_dot2c_f32_bf16 v163, v73, v73
  v_dot2c_f32_bf16 v162, v74, v166
  v_dot2c_f32_bf16 v163, v74, v74
  v_dot2c_f32_bf16 v162, v75, v166
  v_dot2c_f32_bf16 v163, v75, v75
  s_waitcnt vmcnt(6)
  ds_read_b128 v[84:87], v160 offset:3072
  ds_read_b128 v[88:91], v161 offset:3072
  s_waitcnt lgkmcnt(2)
  v_dot2c_f32_bf16 v162, v76, v166
  v_dot2c_f32_bf16 v163, v76, v76
  v_dot2c_f32_bf16 v162, v77, v166
  v_dot2c_f32_bf16 v163, v77, v77
  v_dot2c_f32_bf16 v162, v78, v166
  v_dot2c_f32_bf16 v163, v78, v78
  v_dot2c_f32_bf16 v162, v79, v166
  v_dot2c_f32_bf16 v163, v79, v79
  v_dot2c_f32_bf16 v162, v80, v166
  v_dot2c_f32_bf16 v163, v80, v80
  v_dot2c_f32_bf16 v162, v81, v166
  v_dot2c_f32_bf16 v163, v81, v81
  v_dot2c_f32_bf16 v162, v82, v166
  v_dot2c_f32_bf16 v163, v82, v82
  v_dot2c_f32_bf16 v162, v83, v166
  v_dot2c_f32_bf16 v163, v83, v83
  s_waitcnt vmcnt(4)
  ds_read_b128 v[92:95], v160 offset:4096
  ds_read_b128 v[96:99], v161 offset:4096
  s_waitcnt lgkmcnt(2)
  v_dot2c_f32_bf16 v162, v84, v166
  v_dot2c_f32_bf16 v163, v84, v84
  v_dot2c_f32_bf16 v162, v85, v166
  v_dot2c_f32_bf16 v163, v85, v85
  v_dot2c_f32_bf16 v162, v86, v166
  v_dot2c_f32_bf16 v163, v86, v86
  v_dot2c_f32_bf16 v162, v87, v166
  v_dot2c_f32_bf16 v163, v87, v87
  v_dot2c_f32_bf16 v162, v88, v166
  v_dot2c_f32_bf16 v163, v88, v88
  v_dot2c_f32_bf16 v162, v89, v166
  v_dot2c_f32_bf16 v163, v89, v89
  v_dot2c_f32_bf16 v162, v90, v166
  v_dot2c_f32_bf16 v163, v90, v90
  v_dot2c_f32_bf16 v162, v91, v166
  v_dot2c_f32_bf16 v163, v91, v91
  s_waitcnt vmcnt(2)
  ds_read_b128 v[100:103], v160 offset:5120
  ds_read_b128 v[104:107], v161 offset:5120
  s_waitcnt lgkmcnt(2)
  v_dot2c_f32_bf16 v162, v92, v166
  v_dot2c_f32_bf16 v163, v92, v92
  v_dot2c_f32_bf16 v162, v93, v166
  v_dot2c_f32_bf16 v163, v93, v93
  v_dot2c_f32_bf16 v162, v94, v166
  v_dot2c_f32_bf16 v163, v94, v94
  v_dot2c_f32_bf16 v162, v95, v166
  v_dot2c_f32_bf16 v163, v95, v95
  v_dot2c_f32_bf16 v162, v96, v166
  v_dot2c_f32_bf16 v163, v96, v96
  v_dot2c_f32_bf16 v162, v97, v166
  v_dot2c_f32_bf16 v163, v97, v97
  v_dot2c_f32_bf16 v162, v98, v166
  v_dot2c_f32_bf16 v163, v98, v98
  v_dot2c_f32_bf16 v162, v99, v166
  v_dot2c_f32_bf16 v163, v99, v99
  s_waitcnt vmcnt(0)
  ds_read_b128 v[108:111], v160 offset:6144
  ds_read_b128 v[112:115], v161 offset:6144
  s_waitcnt lgkmcnt(2)
  v_dot2c_f32_bf16 v162, v100, v166
  v_dot2c_f32_bf16 v163, v100, v100
  v_dot2c_f32_bf16 v162, v101, v166
  v_dot2c_f32_bf16 v163, v101, v101
  v_dot2c_f32_bf16 v162, v102, v166
  v_dot2c_f32_bf16 v163, v102, v102
  v_dot2c_f32_bf16 v162, v103, v166
  v_dot2c_f32_bf16 v163, v103, v103
  v_dot2c_f32_bf16 v162, v104, v166
  v_dot2c_f32_bf16 v163, v104, v104
  v_dot2c_f32_bf16 v162, v105, v166
  v_dot2c_f32_bf16 v163, v105, v105
  v_dot2c_f32_bf16 v162, v106, v166
  v_dot2c_f32_bf16 v163, v106, v106
  v_dot2c_f32_bf16 v162, v107, v166
  v_dot2c_f32_bf16 v163, v107, v107
  s_waitcnt lgkmcnt(0)
  v_dot2c_f32_bf16 v162, v108, v166
  v_dot2c_f32_bf16 v163, v108, v108
  v_dot2c_f32_bf16 v162, v109, v166
  v_dot2c_f32_bf16 v163, v109, v109
  v_dot2c_f32_bf16 v162, v110, v166
  v_dot2c_f32_bf16 v163, v110, v110
  v_dot2c_f32_bf16 v162, v111, v166
  v_dot2c_f32_bf16 v163, v111, v111
  v_dot2c_f32_bf16 v162, v112, v166
  v_dot2c_f32_bf16 v163, v112, v112
  v_dot2c_f32_bf16 v162, v113, v166
  v_dot2c_f32_bf16 v163, v113, v113
  v_dot2c_f32_bf16 v162, v114, v166
  v_dot2c_f32_bf16 v163, v114, v114
  v_dot2c_f32_bf16 v162, v115, v166
  v_dot2c_f32_bf16 v163, v115, v115
  s_nop 1
  v_mov_b32 v116, v162
  v_mov_b32 v117, v163
  s_nop 0
  v_permlane32_swap_b32 v162, v116
  v_permlane32_swap_b32 v163, v117
  v_add_f32 v162, v162, v116
  v_add_f32 v163, v163, v117
  ds_write_b64 v119, v[162:163]
  v_add_u32 v160, s58, v160
  v_add_u32 v161, s58, v161
  s_waitcnt lgkmcnt(0)
  s_barrier
  ds_read_b64 v[116:117], v118
  ds_read_b128 v[4:7], v160 offset:0
  ds_read_b128 v[8:11], v161 offset:0
  ds_read_b128 v[12:15], v160 offset:1024
  ds_read_b128 v[16:19], v161 offset:1024
  ds_read_b128 v[20:23], v160 offset:2048
  ds_read_b128 v[24:27], v161 offset:2048
  ds_read_b128 v[28:31], v160 offset:3072
  ds_read_b128 v[32:35], v161 offset:3072
  ds_read_b128 v[36:39], v160 offset:4096
  ds_read_b128 v[40:43], v161 offset:4096
  ds_read_b128 v[44:47], v160 offset:5120
  ds_read_b128 v[48:51], v161 offset:5120
  ds_read_b128 v[52:55], v160 offset:6144
  ds_read_b128 v[56:59], v161 offset:6144
L_halfj:
  s_waitcnt lgkmcnt(14)
  v_add_f32 v162, v162, v116
  v_add_f32 v163, v163, v117
  v_mul_f32 v162, 0x3b124925, v162
  v_mul_f32 v163, 0x3b124925, v163
  v_fma_f32 v163, -v162, v162, v163
  v_max_f32 v163, 0, v163
  v_add_f32 v163, 0x3727c5ac, v163
  v_rsq_f32 v164, v163
  s_nop 0
  v_mul_f32 v162, v162, v164
  v_sub_f32 v165, 0, v162
  s_waitcnt lgkmcnt(0)
  s_barrier
  v_mov_b32 v160, v164
  v_mov_b32 v161, v164
  v_mov_b32 v162, v165
  v_mov_b32 v163, v165
  v_lshlrev_b32 v116, 16, v4
  v_and_b32 v117, s66, v4
  v_lshlrev_b32 v118, 16, v5
  v_and_b32 v119, s66, v5
  v_lshlrev_b32 v120, 16, v6
  v_and_b32 v121, s66, v6
  v_lshlrev_b32 v122, 16, v7
  v_and_b32 v123, s66, v7
  v_lshlrev_b32 v124, 16, v8
  v_and_b32 v125, s66, v8
  v_lshlrev_b32 v126, 16, v9
  v_and_b32 v127, s66, v9
  v_lshlrev_b32 v128, 16, v10
  v_and_b32 v129, s66, v10
  v_lshlrev_b32 v130, 16, v11
  v_and_b32 v131, s66, v11
  v_pk_fma_f32 v[116:117], v[116:117], v[160:161], v[162:163]
  v_pk_fma_f32 v[118:119], v[118:119], v[160:161], v[162:163]
  v_pk_fma_f32 v[120:121], v[120:121], v[160:161], v[162:163]
  v_pk_fma_f32 v[122:123], v[122:123], v[160:161], v[162:163]
  v_pk_fma_f32 v[124:125], v[124:125], v[160:161], v[162:163]
  v_pk_fma_f32 v[126:127], v[126:127], v[160:161], v[162:163]
  v_pk_fma_f32 v[128:129], v[128:129], v[160:161], v[162:163]
  v_pk_fma_f32 v[130:131], v[130:131], v[160:161], v[162:163]
  v_cvt_pk_bf16_f32 v4, v116, v117
  v_cvt_pk_bf16_f32 v5, v118, v119
  v_cvt_pk_bf16_f32 v6, v120, v121
  v_cvt_pk_bf16_f32 v7, v122, v123
  v_cvt_pk_bf16_f32 v8, v124, v125
  v_cvt_pk_bf16_f32 v9, v126, v127
  v_cvt_pk_bf16_f32 v10, v128, v129
  v_cvt_pk_bf16_f32 v11, v130, v131
  v_lshlrev_b32 v132, 16, v12
  v_and_b32 v133, s66, v12
  v_lshlrev_b32 v134, 16, v13
  v_and_b32 v135, s66, v13
  v_lshlrev_b32 v136, 16, v14
  v_and_b32 v137, s66, v14
  v_lshlrev_b32 v138, 16, v15
  v_and_b32 v139, s66, v15
  v_lshlrev_b32 v140, 16, v16
  v_and_b32 v141, s66, v16
  v_lshlrev_b32 v142, 16, v17
  v_and_b32 v143, s66, v17
  v_lshlrev_b32 v144, 16, v18
  v_and_b32 v145, s66, v18
  v_lshlrev_b32 v146, 16, v19
  v_and_b32 v147, s66, v19
  v_pk_fma_f32 v[132:133], v[132:133], v[160:161], v[162:163]
  v_pk_fma_f32 v[134:135], v[134:135], v[160:161], v[162:163]
  v_pk_fma_f32 v[136:137], v[136:137], v[160:161], v[162:163]
  v_pk_fma_f32 v[138:139], v[138:139], v[160:161], v[162:163]
  v_pk_fma_f32 v[140:141], v[140:141], v[160:161], v[162:163]
  v_pk_fma_f32 v[142:143], v[142:143], v[160:161], v[162:163]
  v_pk_fma_f32 v[144:145], v[144:145], v[160:161], v[162:163]
  v_pk_fma_f32 v[146:147], v[146:147], v[160:161], v[162:163]
  v_cvt_pk_bf16_f32 v12, v132, v133
  v_cvt_pk_bf16_f32 v13, v134, v135
  v_cvt_pk_bf16_f32 v14, v136, v137
  v_cvt_pk_bf16_f32 v15, v138, v139
  v_cvt_pk_bf16_f32 v16, v140, v141
  v_cvt_pk_bf16_f32 v17, v142, v143
  v_cvt_pk_bf16_f32 v18, v144, v145
  v_cvt_pk_bf16_f32 v19, v146, v147
  v_lshlrev_b32 v116, 16, v20
  v_and_b32 v117, s66, v20
  v_lshlrev_b32 v118, 16, v21
  v_and_b32 v119, s66, v21
  v_lshlrev_b32 v120, 16, v22
  v_and_b32 v121, s66, v22
  v_lshlrev_b32 v122, 16, v23
  v_and_b32 v123, s66, v23
  v_lshlrev_b32 v124, 16, v24
  v_and_b32 v125, s66, v24
  v_lshlrev_b32 v126, 16, v25
  v_and_b32 v127, s66, v25
  v_lshlrev_b32 v128, 16, v26
  v_and_b32 v129, s66, v26
  v_lshlrev_b32 v130, 16, v27
  v_and_b32 v131, s66, v27
  v_pk_fma_f32 v[116:117], v[116:117], v[160:161], v[162:163]
  v_pk_fma_f32 v[118:119], v[118:119], v[160:161], v[162:163]
  v_pk_fma_f32 v[120:121], v[120:121], v[160:161], v[162:163]
  v_pk_fma_f32 v[122:123], v[122:123], v[160:161], v[162:163]
  v_pk_fma_f32 v[124:125], v[124:125], v[160:161], v[162:163]
  v_pk_fma_f32 v[126:127], v[126:127], v[160:161], v[162:163]
  v_pk_fma_f32 v[128:129], v[128:129], v[160:161], v[162:163]
  v_pk_fma_f32 v[130:131], v[130:131], v[160:161], v[162:163]
  v_cvt_pk_bf16_f32 v20, v116, v117
  v_cvt_pk_bf16_f32 v21, v118, v119
  v_cvt_pk_bf16_f32 v22, v120, v121
  v_cvt_pk_bf16_f32 v23, v122, v123
  v_cvt_pk_bf16_f32 v24, v124, v125
  v_cvt_pk_bf16_f32 v25, v126, v127
  v_cvt_pk_bf16_f32 v26, v128, v129
  v_cvt_pk_bf16_f32 v27, v130, v131
  v_lshlrev_b32 v132, 16, v28
  v_and_b32 v133, s66, v28
  v_lshlrev_b32 v134, 16, v29
  v_and_b32 v135, s66, v29
  v_lshlrev_b32 v136, 16, v30
  v_and_b32 v137, s66, v30
  v_lshlrev_b32 v138, 16, v31
  v_and_b32 v139, s66, v31
  v_lshlrev_b32 v140, 16, v32
  v_and_b32 v141, s66, v32
  v_lshlrev_b32 v142, 16, v33
  v_and_b32 v143, s66, v33
  v_lshlrev_b32 v144, 16, v34
  v_and_b32 v145, s66, v34
  v_lshlrev_b32 v146, 16, v35
  v_and_b32 v147, s66, v35
  v_pk_fma_f32 v[132:133], v[132:133], v[160:161], v[162:163]
  v_pk_fma_f32 v[134:135], v[134:135], v[160:161], v[162:163]
  v_pk_fma_f32 v[136:137], v[136:137], v[160:161], v[162:163]
  v_pk_fma_f32 v[138:139], v[138:139], v[160:161], v[162:163]
  v_pk_fma_f32 v[140:141], v[140:141], v[160:161], v[162:163]
  v_pk_fma_f32 v[142:143], v[142:143], v[160:161], v[162:163]
  v_pk_fma_f32 v[144:145], v[144:145], v[160:161], v[162:163]
  v_pk_fma_f32 v[146:147], v[146:147], v[160:161], v[162:163]
  v_cvt_pk_bf16_f32 v28, v132, v133
  v_cvt_pk_bf16_f32 v29, v134, v135
  v_cvt_pk_bf16_f32 v30, v136, v137
  v_cvt_pk_bf16_f32 v31, v138, v139
  v_cvt_pk_bf16_f32 v32, v140, v141
  v_cvt_pk_bf16_f32 v33, v142, v143
  v_cvt_pk_bf16_f32 v34, v144, v145
  v_cvt_pk_bf16_f32 v35, v146, v147
  v_lshlrev_b32 v116, 16, v36
  v_and_b32 v117, s66, v36
  v_lshlrev_b32 v118, 16, v37
  v_and_b32 v119, s66, v37
  v_lshlrev_b32 v120, 16, v38
  v_and_b32 v121, s66, v38
  v_lshlrev_b32 v122, 16, v39
  v_and_b32 v123, s66, v39
  v_pk_fma_f32 v[116:117], v[116:117], v[160:161], v[162:163]
  v_pk_fma_f32 v[118:119], v[118:119], v[160:161], v[162:163]
  v_pk_fma_f32 v[120:121], v[120:121], v[160:161], v[162:163]
  v_pk_fma_f32 v[122:123], v[122:123], v[160:161], v[162:163]
  v_cvt_pk_bf16_f32 v36, v116, v117
  v_cvt_pk_bf16_f32 v37, v118, v119
  v_cvt_pk_bf16_f32 v38, v120, v121
  v_cvt_pk_bf16_f32 v39, v122, v123
  s_barrier
  s_cmp_eq_u32 s8, 1
  s_cbranch_scc1 L_btype
  ds_read_b64_tr_b16 v[148:149], v1 offset:0
  ds_read_b64_tr_b16 v[150:151], v1 offset:256
  ds_read_b64_tr_b16 v[152:153], v1 offset:8192
  ds_read_b64_tr_b16 v[154:155], v1 offset:8448
  ds_read_b64_tr_b16 v[156:157], v1 offset:2048
  ds_read_b64_tr_b16 v[158:159], v1 offset:2304
  s_waitcnt lgkmcnt(4)
  v_mfma_f32_32x32x16_bf16 v[116:131], v[4:7], v[148:151], 0
  ds_read_b64_tr_b16 v[148:149], v1 offset:10240
  ds_read_b64_tr_b16 v[150:151], v1 offset:10496
  v_lshlrev_b32 v160, 16, v40
  v_and_b32 v161, s66, v40
  v_lshlrev_b32 v162, 16, v41
  v_and_b32 v163, s66, v41
  v_fma_f32 v160, v160, v164, v165
  v_fma_f32 v161, v161, v164, v165
  v_lshlrev_b32 v166, 16, v42
  s_waitcnt lgkmcnt(4)
  v_mfma_f32_32x32x16_bf16 v[132:147], v[152:155], v[4:7], 0
  ds_read_b64_tr_b16 v[152:153], v1 offset:4096
  ds_read_b64_tr_b16 v[154:155], v1 offset:4352
  v_and_b32 v167, s66, v42
  v_fma_f32 v162, v162, v164, v165
  v_fma_f32 v163, v163, v164, v165
  v_cvt_pk_bf16_f32 v40, v160, v161
  v_lshlrev_b32 v160, 16, v43
  v_and_b32 v161, s66, v43
  v_fma_f32 v166, v166, v164, v165
  v_fma_f32 v167, v167, v164, v165
  s_waitcnt lgkmcnt(4)
  v_mfma_f32_32x32x16_bf16 v[116:131], v[8:11], v[156:159], v[116:131]
  ds_read_b64_tr_b16 v[156:157], v1 offset:12288
  ds_read_b64_tr_b16 v[158:159], v1 offset:12544
  v_cvt_pk_bf16_f32 v41, v162, v163
  v_lshlrev_b32 v162, 16, v44
  v_and_b32 v163, s66, v44
  v_fma_f32 v160, v160, v164, v165
  v_fma_f32 v161, v161, v164, v165
  v_cvt_pk_bf16_f32 v42, v166, v167
  v_lshlrev_b32 v166, 16, v45
  s_waitcnt lgkmcnt(4)
  v_mfma_f32_32x32x16_bf16 v[132:147], v[148:151], v[8:11], v[132:147]
  ds_read_b64_tr_b16 v[148:149], v1 offset:6144
  ds_read_b64_tr_b16 v[150:151], v1 offset:6400
  v_and_b32 v167, s66, v45
  v_fma_f32 v162, v162, v164, v165
  v_fma_f32 v163, v163, v164, v165
  v_cvt_pk_bf16_f32 v43, v160, v161
  v_lshlrev_b32 v160, 16, v46
  v_and_b32 v161, s66, v46
  v_fma_f32 v166, v166, v164, v165
  s_waitcnt lgkmcnt(4)
  v_mfma_f32_32x32x16_bf16 v[116:131], v[12:15], v[152:155], v[116:131]
  ds_read_b64_tr_b16 v[152:153], v1 offset:14336
  ds_read_b64_tr_b16 v[154:155], v1 offset:14592
  v_add_u32 v1, 147456, v3
  v_fma_f32 v167, v167, v164, v165
  v_cvt_pk_bf16_f32 v44, v162, v163
  v_lshlrev_b32 v162, 16, v47
  v_and_b32 v163, s66, v47
  v_fma_f32 v160, v160, v164, v165
  v_fma_f32 v161, v161, v164, v165
  v_cvt_pk_bf16_f32 v45, v166, v167
  v_lshlrev_b32 v166, 16, v48
  s_waitcnt lgkmcnt(4)
  v_mfma_f32_32x32x16_bf16 v[132:147], v[156:159], v[12:15], v[132:147]
  ds_read_b64_tr_b16 v[156:157], v2 offset:0
  ds_read_b64_tr_b16 v[158:159], v2 offset:256
  v_and_b32 v167, s66, v48
  v_fma_f32 v162, v162, v164, v165
  v_fma_f32 v163, v163, v164, v165
  v_cvt_pk_bf16_f32 v46, v160, v161
  v_lshlrev_b32 v160, 16, v49
  v_and_b32 v161, s66, v49
  v_fma_f32 v166, v166, v164, v165
  s_waitcnt lgkmcnt(4)
  v_mfma_f32_32x32x16_bf16 v[116:131], v[16:19], v[148:151], v[116:131]
  ds_read_b64_tr_b16 v[148:149], v2 offset:8192
  ds_read_b64_tr_b16 v[150:151], v2 offset:8448
  v_fma_f32 v167, v167, v164, v165
  v_cvt_pk_bf16_f32 v47, v162, v163
  v_lshlrev_b32 v162, 16, v50
  v_and_b32 v163, s66, v50
  v_fma_f32 v160, v160, v164, v165
  v_fma_f32 v161, v161, v164, v165
  v_cvt_pk_bf16_f32 v48, v166, v167
  s_waitcnt lgkmcnt(4)
  v_mfma_f32_32x32x16_bf16 v[132:147], v[152:155], v[16:19], v[132:147]
  s_barrier
  ds_read_b64_tr_b16 v[152:153], v2 offset:2048
  ds_read_b64_tr_b16 v[154:155], v2 offset:2304
  v_lshlrev_b32 v166, 16, v51
  v_and_b32 v167, s66, v51
  v_fma_f32 v162, v162, v164, v165
  v_fma_f32 v163, v163, v164, v165
  v_cvt_pk_bf16_f32 v49, v160, v161
  v_lshlrev_b32 v160, 16, v52
  v_and_b32 v161, s66, v52
  s_waitcnt lgkmcnt(4)
  v_mfma_f32_32x32x16_bf16 v[116:131], v[20:23], v[156:159], v[116:131]
  ds_read_b64_tr_b16 v[156:157], v2 offset:10240
  ds_read_b64_tr_b16 v[158:159], v2 offset:10496
  v_fma_f32 v166, v166, v164, v165
  v_fma_f32 v167, v167, v164, v165
  v_cvt_pk_bf16_f32 v50, v162, v163
  v_lshlrev_b32 v162, 16, v53
  v_and_b32 v163, s66, v53
  v_fma_f32 v160, v160, v164, v165
  v_fma_f32 v161, v161, v164, v165
  v_cvt_pk_bf16_f32 v51, v166, v167
  s_waitcnt lgkmcnt(4)
  v_mfma_f32_32x32x16_bf16 v[132:147], v[148:151], v[20:23], v[132:147]
  ds_read_b64_tr_b16 v[148:149], v2 offset:4096
  ds_read_b64_tr_b16 v[150:151], v2 offset:4352
  v_lshlrev_b32 v166, 16, v54
  v_and_b32 v167, s66, v54
  v_fma_f32 v162, v162, v164, v165
  v_fma_f32 v163, v163, v164, v165
  v_cvt_pk_bf16_f32 v52, v160, v161
  v_lshlrev_b32 v160, 16, v55
  v_and_b32 v161, s66, v55
  s_waitcnt lgkmcnt(4)
  v_mfma_f32_32x32x16_bf16 v[116:131], v[24:27], v[152:155], v[116:131]
  ds_read_b64_tr_b16 v[152:153], v2 offset:12288
  ds_read_b64_tr_b16 v[154:155], v2 offset:12544
  v_fma_f32 v166, v166, v164, v165
  v_fma_f32 v167, v167, v164, v165
  v_cvt_pk_bf16_f32 v53, v162, v163
  v_lshlrev_b32 v162, 16, v56
  v_and_b32 v163, s66, v56
  v_fma_f32 v160, v160, v164, v165
  v_fma_f32 v161, v161, v164, v165
  s_waitcnt lgkmcnt(4)
  v_mfma_f32_32x32x16_bf16 v[132:147], v[156:159], v[24:27], v[132:147]
  ds_read_b64_tr_b16 v[156:157], v2 offset:6144
  ds_read_b64_tr_b16 v[158:159], v2 offset:6400
  v_cvt_pk_bf16_f32 v54, v166, v167
  v_lshlrev_b32 v166, 16, v57
  v_and_b32 v167, s66, v57
  v_fma_f32 v162, v162, v164, v165
  v_fma_f32 v163, v163, v164, v165
  v_cvt_pk_bf16_f32 v55, v160, v161
  v_lshlrev_b32 v160, 16, v58
  v_and_b32 v161, s66, v58
  s_waitcnt lgkmcnt(4)
  v_mfma_f32_32x32x16_bf16 v[116:131], v[28:31], v[148:151], v[116:131]
  ds_read_b64_tr_b16 v[148:149], v2 offset:14336
  ds_read_b64_tr_b16 v[150:151], v2 offset:14592
  v_add_u32 v2, 0, v3
  v_fma_f32 v166, v166, v164, v165
  v_fma_f32 v167, v167, v164, v165
  v_cvt_pk_bf16_f32 v56, v162, v163
  v_lshlrev_b32 v162, 16, v59
  v_and_b32 v163, s66, v59
  v_fma_f32 v160, v160, v164, v165
  v_fma_f32 v161, v161, v164, v165
  s_waitcnt lgkmcnt(4)
  v_mfma_f32_32x32x16_bf16 v[132:147], v[152:155], v[28:31], v[132:147]
  ds_read_b64_tr_b16 v[152:153], v1 offset:0
  ds_read_b64_tr_b16 v[154:155], v1 offset:256
  v_cvt_pk_bf16_f32 v57, v166, v167
  v_lshlrev_b32 v166, 16, v60
  v_and_b32 v167, s66, v60
  v_fma_f32 v162, v162, v164, v165
  v_fma_f32 v163, v163, v164, v165
  v_cvt_pk_bf16_f32 v58, v160, v161
  v_lshlrev_b32 v160, 16, v61
  s_waitcnt lgkmcnt(4)
  v_mfma_f32_32x32x16_bf16 v[116:131], v[32:35], v[156:159], v[116:131]
  ds_read_b64_tr_b16 v[156:157], v1 offset:8192
  ds_read_b64_tr_b16 v[158:159], v1 offset:8448
  v_and_b32 v161, s66, v61
  v_fma_f32 v166, v166, v164, v165
  v_fma_f32 v167, v167, v164, v165
  v_cvt_pk_bf16_f32 v59, v162, v163
  v_lshlrev_b32 v162, 16, v62
  v_and_b32 v163, s66, v62
  v_fma_f32 v160, v160, v164, v165
  v_fma_f32 v161, v161, v164, v165
  s_waitcnt lgkmcnt(4)
  v_mfma_f32_32x32x16_bf16 v[132:147], v[148:151], v[32:35], v[132:147]
  s_barrier
  ds_read_b64_tr_b16 v[148:149], v1 offset:2048
  ds_read_b64_tr_b16 v[150:151], v1 offset:2304
  v_cvt_pk_bf16_f32 v60, v166, v167
  v_lshlrev_b32 v166, 16, v63
  v_and_b32 v167, s66, v63
  v_fma_f32 v162, v162, v164, v165
  v_fma_f32 v163, v163, v164, v165
  v_cvt_pk_bf16_f32 v61, v160, v161
  v_lshlrev_b32 v160, 16, v64
  s_waitcnt lgkmcnt(4)
  v_mfma_f32_32x32x16_bf16 v[116:131], v[36:39], v[152:155], v[116:131]
  ds_read_b64_tr_b16 v[152:153], v1 offset:10240
  ds_read_b64_tr_b16 v[154:155], v1 offset:10496
  v_and_b32 v161, s66, v64
  v_fma_f32 v166, v166, v164, v165
  v_fma_f32 v167, v167, v164, v165
  v_cvt_pk_bf16_f32 v62, v162, v163
  v_lshlrev_b32 v162, 16, v65
  v_and_b32 v163, s66, v65
  v_fma_f32 v160, v160, v164, v165
  s_waitcnt lgkmcnt(4)
  v_mfma_f32_32x32x16_bf16 v[132:147], v[156:159], v[36:39], v[132:147]
  ds_read_b64_tr_b16 v[156:157], v1 offset:4096
  ds_read_b64_tr_b16 v[158:159], v1 offset:4352
  v_fma_f32 v161, v161, v164, v165
  v_cvt_pk_bf16_f32 v63, v166, v167
  v_lshlrev_b32 v166, 16, v66
  v_and_b32 v167, s66, v66
  v_fma_f32 v162, v162, v164, v165
  v_fma_f32 v163, v163, v164, v165
  v_cvt_pk_bf16_f32 v64, v160, v161
  v_lshlrev_b32 v160, 16, v67
  s_waitcnt lgkmcnt(4)
  v_mfma_f32_32x32x16_bf16 v[116:131], v[40:43], v[148:151], v[116:131]
  ds_read_b64_tr_b16 v[148:149], v1 offset:12288
  ds_read_b64_tr_b16 v[150:151], v1 offset:12544
  v_and_b32 v161, s66, v67
  v_fma_f32 v166, v166, v164, v165
  v_fma_f32 v167, v167, v164, v165
  v_cvt_pk_bf16_f32 v65, v162, v163
  v_lshlrev_b32 v162, 16, v68
  v_and_b32 v163, s66, v68
  v_fma_f32 v160, v160, v164, v165
  s_waitcnt lgkmcnt(4)
  v_mfma_f32_32x32x16_bf16 v[132:147], v[152:155], v[40:43], v[132:147]
  ds_read_b64_tr_b16 v[152:153], v1 offset:6144
  ds_read_b64_tr_b16 v[154:155], v1 offset:6400
  v_fma_f32 v161, v161, v164, v165
  v_cvt_pk_bf16_f32 v66, v166, v167
  v_lshlrev_b32 v166, 16, v69
  v_and_b32 v167, s66, v69
  v_fma_f32 v162, v162, v164, v165
  v_fma_f32 v163, v163, v164, v165
  v_cvt_pk_bf16_f32 v67, v160, v161
  s_waitcnt lgkmcnt(4)
  v_mfma_f32_32x32x16_bf16 v[116:131], v[44:47], v[156:159], v[116:131]
  ds_read_b64_tr_b16 v[156:157], v1 offset:14336
  ds_read_b64_tr_b16 v[158:159], v1 offset:14592
  v_add_u32 v1, 16384, v3
  v_lshlrev_b32 v160, 16, v70
  v_and_b32 v161, s66, v70
  v_fma_f32 v166, v166, v164, v165
  v_fma_f32 v167, v167, v164, v165
  v_cvt_pk_bf16_f32 v68, v162, v163
  v_lshlrev_b32 v162, 16, v71
  v_and_b32 v163, s66, v71
  s_waitcnt lgkmcnt(4)
  v_mfma_f32_32x32x16_bf16 v[132:147], v[148:151], v[44:47], v[132:147]
  ds_read_b64_tr_b16 v[148:149], v2 offset:0
  ds_read_b64_tr_b16 v[150:151], v2 offset:256
  v_fma_f32 v160, v160, v164, v165
  v_fma_f32 v161, v161, v164, v165
  v_cvt_pk_bf16_f32 v69, v166, v167
  v_lshlrev_b32 v166, 16, v72
  v_and_b32 v167, s66, v72
  v_fma_f32 v162, v162, v164, v165
  v_fma_f32 v163, v163, v164, v165
  v_cvt_pk_bf16_f32 v70, v160, v161
  s_waitcnt lgkmcnt(4)
  v_mfma_f32_32x32x16_bf16 v[116:131], v[48:51], v[152:155], v[116:131]
  ds_read_b64_tr_b16 v[152:153], v2 offset:8192
  ds_read_b64_tr_b16 v[154:155], v2 offset:8448
  v_lshlrev_b32 v160, 16, v73
  v_and_b32 v161, s66, v73
  v_fma_f32 v166, v166, v164, v165
  v_fma_f32 v167, v167, v164, v165
  v_cvt_pk_bf16_f32 v71, v162, v163
  v_lshlrev_b32 v162, 16, v74
  v_and_b32 v163, s66, v74
  s_waitcnt lgkmcnt(4)
  v_mfma_f32_32x32x16_bf16 v[132:147], v[156:159], v[48:51], v[132:147]
  s_barrier
  ds_read_b64_tr_b16 v[156:157], v2 offset:2048
  ds_read_b64_tr_b16 v[158:159], v2 offset:2304
  v_fma_f32 v160, v160, v164, v165
  v_fma_f32 v161, v161, v164, v165
  v_cvt_pk_bf16_f32 v72, v166, v167
  v_lshlrev_b32 v166, 16, v75
  v_and_b32 v167, s66, v75
  v_fma_f32 v162, v162, v164, v165
  v_fma_f32 v163, v163, v164, v165
  s_waitcnt lgkmcnt(4)
  v_mfma_f32_32x32x16_bf16 v[116:131], v[52:55], v[148:151], v[116:131]
  ds_read_b64_tr_b16 v[148:149], v2 offset:10240
  ds_read_b64_tr_b16 v[150:151], v2 offset:10496
  v_cvt_pk_bf16_f32 v73, v160, v161
  v_lshlrev_b32 v160, 16, v76
  v_and_b32 v161, s66, v76
  v_fma_f32 v166, v166, v164, v165
  v_fma_f32 v167, v167, v164, v165
  v_cvt_pk_bf16_f32 v74, v162, v163
  v_lshlrev_b32 v162, 16, v77
  v_and_b32 v163, s66, v77
  s_waitcnt lgkmcnt(4)
  v_mfma_f32_32x32x16_bf16 v[132:147], v[152:155], v[52:55], v[132:147]
  ds_read_b64_tr_b16 v[152:153], v2 offset:4096
  ds_read_b64_tr_b16 v[154:155], v2 offset:4352
  v_fma_f32 v160, v160, v164, v165
  v_fma_f32 v161, v161, v164, v165
  v_cvt_pk_bf16_f32 v75, v166, v167
  v_lshlrev_b32 v166, 16, v78
  v_and_b32 v167, s66, v78
  v_fma_f32 v162, v162, v164, v165
  v_fma_f32 v163, v163, v164, v165
  s_waitcnt lgkmcnt(4)
  v_mfma_f32_32x32x16_bf16 v[116:131], v[56:59], v[156:159], v[116:131]
  ds_read_b64_tr_b16 v[156:157], v2 offset:12288
  ds_read_b64_tr_b16 v[158:159], v2 offset:12544
  v_cvt_pk_bf16_f32 v76, v160, v161
  v_lshlrev_b32 v160, 16, v79
  v_and_b32 v161, s66, v79
  v_fma_f32 v166, v166, v164, v165
  v_fma_f32 v167, v167, v164, v165
  v_cvt_pk_bf16_f32 v77, v162, v163
  v_lshlrev_b32 v162, 16, v80
  s_waitcnt lgkmcnt(4)
  v_mfma_f32_32x32x16_bf16 v[132:147], v[148:151], v[56:59], v[132:147]
  ds_read_b64_tr_b16 v[148:149], v2 offset:6144
  ds_read_b64_tr_b16 v[150:151], v2 offset:6400
  v_and_b32 v163, s66, v80
  v_fma_f32 v160, v160, v164, v165
  v_fma_f32 v161, v161, v164, v165
  v_cvt_pk_bf16_f32 v78, v166, v167
  v_lshlrev_b32 v166, 16, v81
  v_and_b32 v167, s66, v81
  v_fma_f32 v162, v162, v164, v165
  v_fma_f32 v163, v163, v164, v165
  s_waitcnt lgkmcnt(4)
  v_mfma_f32_32x32x16_bf16 v[116:131], v[60:63], v[152:155], v[116:131]
  ds_read_b64_tr_b16 v[152:153], v2 offset:14336
  ds_read_b64_tr_b16 v[154:155], v2 offset:14592
  v_add_u32 v2, 32768, v3
  v_cvt_pk_bf16_f32 v79, v160, v161
  v_lshlrev_b32 v160, 16, v82
  v_and_b32 v161, s66, v82
  v_fma_f32 v166, v166, v164, v165
  v_fma_f32 v167, v167, v164, v165
  v_cvt_pk_bf16_f32 v80, v162, v163
  v_lshlrev_b32 v162, 16, v83
  s_waitcnt lgkmcnt(4)
  v_mfma_f32_32x32x16_bf16 v[132:147], v[156:159], v[60:63], v[132:147]
  ds_read_b64_tr_b16 v[156:157], v1 offset:0
  ds_read_b64_tr_b16 v[158:159], v1 offset:256
  v_and_b32 v163, s66, v83
  v_fma_f32 v160, v160, v164, v165
  v_fma_f32 v161, v161, v164, v165
  v_cvt_pk_bf16_f32 v81, v166, v167
  v_lshlrev_b32 v166, 16, v84
  v_and_b32 v167, s66, v84
  v_fma_f32 v162, v162, v164, v165
  s_waitcnt lgkmcnt(4)
  v_mfma_f32_32x32x16_bf16 v[116:131], v[64:67], v[148:151], v[116:131]
  ds_read_b64_tr_b16 v[148:149], v1 offset:8192
  ds_read_b64_tr_b16 v[150:151], v1 offset:8448
  v_fma_f32 v163, v163, v164, v165
  v_cvt_pk_bf16_f32 v82, v160, v161
  v_lshlrev_b32 v160, 16, v85
  v_and_b32 v161, s66, v85
  v_fma_f32 v166, v166, v164, v165
  v_fma_f32 v167, v167, v164, v165
  v_cvt_pk_bf16_f32 v83, v162, v163
  v_lshlrev_b32 v162, 16, v86
  s_waitcnt lgkmcnt(4)
  v_mfma_f32_32x32x16_bf16 v[132:147], v[152:155], v[64:67], v[132:147]
  s_barrier
  ds_read_b64_tr_b16 v[152:153], v1 offset:2048
  ds_read_b64_tr_b16 v[154:155], v1 offset:2304
  v_and_b32 v163, s66, v86
  v_fma_f32 v160, v160, v164, v165
  v_fma_f32 v161, v161, v164, v165
  v_cvt_pk_bf16_f32 v84, v166, v167
  v_lshlrev_b32 v166, 16, v87
  v_and_b32 v167, s66, v87
  v_fma_f32 v162, v162, v164, v165
  s_waitcnt lgkmcnt(4)
  v_mfma_f32_32x32x16_bf16 v[116:131], v[68:71], v[156:159], v[116:131]
  ds_read_b64_tr_b16 v[156:157], v1 offset:10240
  ds_read_b64_tr_b16 v[158:159], v1 offset:10496
  v_fma_f32 v163, v163, v164, v165
  v_cvt_pk_bf16_f32 v85, v160, v161
  v_lshlrev_b32 v160, 16, v88
  v_and_b32 v161, s66, v88
  v_fma_f32 v166, v166, v164, v165
  v_fma_f32 v167, v167, v164, v165
  v_cvt_pk_bf16_f32 v86, v162, v163
  s_waitcnt lgkmcnt(4)
  v_mfma_f32_32x32x16_bf16 v[132:147], v[148:151], v[68:71], v[132:147]
  ds_read_b64_tr_b16 v[148:149], v1 offset:4096
  ds_read_b64_tr_b16 v[150:151], v1 offset:4352
  v_lshlrev_b32 v162, 16, v89
  v_and_b32 v163, s66, v89
  v_fma_f32 v160, v160, v164, v165
  v_fma_f32 v161, v161, v164, v165
  v_cvt_pk_bf16_f32 v87, v166, v167
  v_lshlrev_b32 v166, 16, v90
  v_and_b32 v167, s66, v90
  s_waitcnt lgkmcnt(4)
  v_mfma_f32_32x32x16_bf16 v[116:131], v[72:75], v[152:155], v[116:131]
  ds_read_b64_tr_b16 v[152:153], v1 offset:12288
  ds_read_b64_tr_b16 v[154:155], v1 offset:12544
  v_fma_f32 v162, v162, v164, v165
  v_fma_f32 v163, v163, v164, v165
  v_cvt_pk_bf16_f32 v88, v160, v161
  v_lshlrev_b32 v160, 16, v91
  v_and_b32 v161, s66, v91
  v_fma_f32 v166, v166, v164, v165
  v_fma_f32 v167, v167, v164, v165
  v_cvt_pk_bf16_f32 v89, v162, v163
  s_waitcnt lgkmcnt(4)
  v_mfma_f32_32x32x16_bf16 v[132:147], v[156:159], v[72:75], v[132:147]
  ds_read_b64_tr_b16 v[156:157], v1 offset:6144
  ds_read_b64_tr_b16 v[158:159], v1 offset:6400
  v_lshlrev_b32 v162, 16, v92
  v_and_b32 v163, s66, v92
  v_fma_f32 v160, v160, v164, v165
  v_fma_f32 v161, v161, v164, v165
  v_cvt_pk_bf16_f32 v90, v166, v167
  v_lshlrev_b32 v166, 16, v93
  v_and_b32 v167, s66, v93
  s_waitcnt lgkmcnt(4)
  v_mfma_f32_32x32x16_bf16 v[116:131], v[76:79], v[148:151], v[116:131]
  ds_read_b64_tr_b16 v[148:149], v1 offset:14336
  ds_read_b64_tr_b16 v[150:151], v1 offset:14592
  v_add_u32 v1, 49152, v3
  v_fma_f32 v162, v162, v164, v165
  v_fma_f32 v163, v163, v164, v165
  v_cvt_pk_bf16_f32 v91, v160, v161
  v_lshlrev_b32 v160, 16, v94
  v_and_b32 v161, s66, v94
  v_fma_f32 v166, v166, v164, v165
  v_fma_f32 v167, v167, v164, v165
  s_waitcnt lgkmcnt(4)
  v_mfma_f32_32x32x16_bf16 v[132:147], v[152:155], v[76:79], v[132:147]
  ds_read_b64_tr_b16 v[152:153], v2 offset:0
  ds_read_b64_tr_b16 v[154:155], v2 offset:256
  v_cvt_pk_bf16_f32 v92, v162, v163
  v_lshlrev_b32 v162, 16, v95
  v_and_b32 v163, s66, v95
  v_fma_f32 v160, v160, v164, v165
  v_fma_f32 v161, v161, v164, v165
  v_cvt_pk_bf16_f32 v93, v166, v167
  v_lshlrev_b32 v166, 16, v96
  v_and_b32 v167, s66, v96
  s_waitcnt lgkmcnt(4)
  v_mfma_f32_32x32x16_bf16 v[116:131], v[80:83], v[156:159], v[116:131]
  ds_read_b64_tr_b16 v[156:157], v2 offset:8192
  ds_read_b64_tr_b16 v[158:159], v2 offset:8448
  v_fma_f32 v162, v162, v164, v165
  v_fma_f32 v163, v163, v164, v165
  v_cvt_pk_bf16_f32 v94, v160, v161
  v_lshlrev_b32 v160, 16, v97
  v_and_b32 v161, s66, v97
  v_fma_f32 v166, v166, v164, v165
  v_fma_f32 v167, v167, v164, v165
  s_waitcnt lgkmcnt(4)
  v_mfma_f32_32x32x16_bf16 v[132:147], v[148:151], v[80:83], v[132:147]
  s_barrier
  ds_read_b64_tr_b16 v[148:149], v2 offset:2048
  ds_read_b64_tr_b16 v[150:151], v2 offset:2304
  v_cvt_pk_bf16_f32 v95, v162, v163
  v_lshlrev_b32 v162, 16, v98
  v_and_b32 v163, s66, v98
  v_fma_f32 v160, v160, v164, v165
  v_fma_f32 v161, v161, v164, v165
  v_cvt_pk_bf16_f32 v96, v166, v167
  v_lshlrev_b32 v166, 16, v99
  s_waitcnt lgkmcnt(4)
  v_mfma_f32_32x32x16_bf16 v[116:131], v[84:87], v[152:155], v[116:131]
  ds_read_b64_tr_b16 v[152:153], v2 offset:10240
  ds_read_b64_tr_b16 v[154:155], v2 offset:10496
  v_and_b32 v167, s66, v99
  v_fma_f32 v162, v162, v164, v165
  v_fma_f32 v163, v163, v164, v165
  v_cvt_pk_bf16_f32 v97, v160, v161
  v_lshlrev_b32 v160, 16, v100
  v_and_b32 v161, s66, v100
  v_fma_f32 v166, v166, v164, v165
  v_fma_f32 v167, v167, v164, v165
  s_waitcnt lgkmcnt(4)
  v_mfma_f32_32x32x16_bf16 v[132:147], v[156:159], v[84:87], v[132:147]
  ds_read_b64_tr_b16 v[156:157], v2 offset:4096
  ds_read_b64_tr_b16 v[158:159], v2 offset:4352
  v_cvt_pk_bf16_f32 v98, v162, v163
  v_lshlrev_b32 v162, 16, v101
  v_and_b32 v163, s66, v101
  v_fma_f32 v160, v160, v164, v165
  v_fma_f32 v161, v161, v164, v165
  v_cvt_pk_bf16_f32 v99, v166, v167
  v_lshlrev_b32 v166, 16, v102
  s_waitcnt lgkmcnt(4)
  v_mfma_f32_32x32x16_bf16 v[116:131], v[88:91], v[148:151], v[116:131]
  ds_read_b64_tr_b16 v[148:149], v2 offset:12288
  ds_read_b64_tr_b16 v[150:151], v2 offset:12544
  v_and_b32 v167, s66, v102
  v_fma_f32 v162, v162, v164, v165
  v_fma_f32 v163, v163, v164, v165
  v_cvt_pk_bf16_f32 v100, v160, v161
  v_lshlrev_b32 v160, 16, v103
  v_and_b32 v161, s66, v103
  v_fma_f32 v166, v166, v164, v165
  s_waitcnt lgkmcnt(4)
  v_mfma_f32_32x32x16_bf16 v[132:147], v[152:155], v[88:91], v[132:147]
  ds_read_b64_tr_b16 v[152:153], v2 offset:6144
  ds_read_b64_tr_b16 v[154:155], v2 offset:6400
  v_fma_f32 v167, v167, v164, v165
  v_cvt_pk_bf16_f32 v101, v162, v163
  v_lshlrev_b32 v162, 16, v104
  v_and_b32 v163, s66, v104
  v_fma_f32 v160, v160, v164, v165
  v_fma_f32 v161, v161, v164, v165
  v_cvt_pk_bf16_f32 v102, v166, v167
  v_lshlrev_b32 v166, 16, v105
  s_waitcnt lgkmcnt(4)
  v_mfma_f32_32x32x16_bf16 v[116:131], v[92:95], v[156:159], v[116:131]
  ds_read_b64_tr_b16 v[156:157], v2 offset:14336
  ds_read_b64_tr_b16 v[158:159], v2 offset:14592
  v_add_u32 v2, 65536, v3
  v_and_b32 v167, s66, v105
  v_fma_f32 v162, v162, v164, v165
  v_fma_f32 v163, v163, v164, v165
  v_cvt_pk_bf16_f32 v103, v160, v161
  v_lshlrev_b32 v160, 16, v106
  v_and_b32 v161, s66, v106
  v_fma_f32 v166, v166, v164, v165
  s_waitcnt lgkmcnt(4)
  v_mfma_f32_32x32x16_bf16 v[132:147], v[148:151], v[92:95], v[132:147]
  ds_read_b64_tr_b16 v[148:149], v1 offset:0
  ds_read_b64_tr_b16 v[150:151], v1 offset:256
  v_fma_f32 v167, v167, v164, v165
  v_cvt_pk_bf16_f32 v104, v162, v163
  v_lshlrev_b32 v162, 16, v107
  v_and_b32 v163, s66, v107
  v_fma_f32 v160, v160, v164, v165
  v_fma_f32 v161, v161, v164, v165
  v_cvt_pk_bf16_f32 v105, v166, v167
  s_waitcnt lgkmcnt(4)
  v_mfma_f32_32x32x16_bf16 v[116:131], v[96:99], v[152:155], v[116:131]
  ds_read_b64_tr_b16 v[152:153], v1 offset:8192
  ds_read_b64_tr_b16 v[154:155], v1 offset:8448
  v_lshlrev_b32 v166, 16, v108
  v_and_b32 v167, s66, v108
  v_fma_f32 v162, v162, v164, v165
  v_fma_f32 v163, v163, v164, v165
  v_cvt_pk_bf16_f32 v106, v160, v161
  v_lshlrev_b32 v160, 16, v109
  v_and_b32 v161, s66, v109
  s_waitcnt lgkmcnt(4)
  v_mfma_f32_32x32x16_bf16 v[132:147], v[156:159], v[96:99], v[132:147]
  s_barrier
  ds_read_b64_tr_b16 v[156:157], v1 offset:2048
  ds_read_b64_tr_b16 v[158:159], v1 offset:2304
  v_fma_f32 v166, v166, v164, v165
  v_fma_f32 v167, v167, v164, v165
  v_cvt_pk_bf16_f32 v107, v162, v163
  v_lshlrev_b32 v162, 16, v110
  v_and_b32 v163, s66, v110
  v_fma_f32 v160, v160, v164, v165
  v_fma_f32 v161, v161, v164, v165
  v_cvt_pk_bf16_f32 v108, v166, v167
  s_waitcnt lgkmcnt(4)
  v_mfma_f32_32x32x16_bf16 v[116:131], v[100:103], v[148:151], v[116:131]
  ds_read_b64_tr_b16 v[148:149], v1 offset:10240
  ds_read_b64_tr_b16 v[150:151], v1 offset:10496
  v_lshlrev_b32 v166, 16, v111
  v_and_b32 v167, s66, v111
  v_fma_f32 v162, v162, v164, v165
  v_fma_f32 v163, v163, v164, v165
  v_cvt_pk_bf16_f32 v109, v160, v161
  v_lshlrev_b32 v160, 16, v112
  v_and_b32 v161, s66, v112
  s_waitcnt lgkmcnt(4)
  v_mfma_f32_32x32x16_bf16 v[132:147], v[152:155], v[100:103], v[132:147]
  ds_read_b64_tr_b16 v[152:153], v1 offset:4096
  ds_read_b64_tr_b16 v[154:155], v1 offset:4352
  v_fma_f32 v166, v166, v164, v165
  v_fma_f32 v167, v167, v164, v165
  v_cvt_pk_bf16_f32 v110, v162, v163
  v_lshlrev_b32 v162, 16, v113
  v_and_b32 v163, s66, v113
  v_fma_f32 v160, v160, v164, v165
  v_fma_f32 v161, v161, v164, v165
  s_waitcnt lgkmcnt(4)
  v_mfma_f32_32x32x16_bf16 v[116:131], v[104:107], v[156:159], v[116:131]
  ds_read_b64_tr_b16 v[156:157], v1 offset:12288
  ds_read_b64_tr_b16 v[158:159], v1 offset:12544
  v_cvt_pk_bf16_f32 v111, v166, v167
  v_lshlrev_b32 v166, 16, v114
  v_and_b32 v167, s66, v114
  v_fma_f32 v162, v162, v164, v165
  v_fma_f32 v163, v163, v164, v165
  v_cvt_pk_bf16_f32 v112, v160, v161
  v_lshlrev_b32 v160, 16, v115
  v_and_b32 v161, s66, v115
  s_waitcnt lgkmcnt(4)
  v_mfma_f32_32x32x16_bf16 v[132:147], v[148:151], v[104:107], v[132:147]
  ds_read_b64_tr_b16 v[148:149], v1 offset:6144
  ds_read_b64_tr_b16 v[150:151], v1 offset:6400
  v_fma_f32 v166, v166, v164, v165
  v_fma_f32 v167, v167, v164, v165
  v_cvt_pk_bf16_f32 v113, v162, v163
  v_fma_f32 v160, v160, v164, v165
  v_fma_f32 v161, v161, v164, v165
  v_cvt_pk_bf16_f32 v114, v166, v167
  v_cvt_pk_bf16_f32 v115, v160, v161
  s_waitcnt lgkmcnt(4)
  v_mfma_f32_32x32x16_bf16 v[116:131], v[108:111], v[152:155], v[116:131]
  ds_read_b64_tr_b16 v[152:153], v1 offset:14336
  ds_read_b64_tr_b16 v[154:155], v1 offset:14592
  v_add_u32 v1, 81920, v3
  s_waitcnt lgkmcnt(4)
  v_mfma_f32_32x32x16_bf16 v[132:147], v[156:159], v[108:111], v[132:147]
  ds_read_b64_tr_b16 v[156:157], v2 offset:0
  ds_read_b64_tr_b16 v[158:159], v2 offset:256
  s_waitcnt lgkmcnt(4)
  v_mfma_f32_32x32x16_bf16 v[116:131], v[112:115], v[148:151], v[116:131]
  ds_read_b64_tr_b16 v[148:149], v2 offset:2048
  ds_read_b64_tr_b16 v[150:151], v2 offset:2304
  s_waitcnt lgkmcnt(4)
  v_mfma_f32_32x32x16_bf16 v[132:147], v[152:155], v[112:115], v[132:147]
  s_barrier
  ds_read_b64_tr_b16 v[152:153], v2 offset:4096
  ds_read_b64_tr_b16 v[154:155], v2 offset:4352
  s_nop 4
  v_cvt_pk_bf16_f32 v160, v116, v117
  v_cvt_pk_bf16_f32 v161, v118, v119
  v_cvt_pk_bf16_f32 v162, v120, v121
  v_cvt_pk_bf16_f32 v163, v122, v123
  v_cvt_pk_bf16_f32 v164, v124, v125
  v_cvt_pk_bf16_f32 v165, v126, v127
  v_cvt_pk_bf16_f32 v166, v128, v129
  v_cvt_pk_bf16_f32 v167, v130, v131
  s_waitcnt lgkmcnt(4)
  v_mfma_f32_32x32x16_bf16 v[116:131], v[156:159], v[4:7], 0
  ds_read_b64_tr_b16 v[156:157], v2 offset:6144
  ds_read_b64_tr_b16 v[158:159], v2 offset:6400
  s_mov_b64 exec, s[56:57]
  v_mov_b32 v160, 0
  v_mov_b32 v161, 0
  v_mov_b32 v162, 0
  v_mov_b32 v163, 0
  v_mov_b32 v164, 0
  v_mov_b32 v165, 0
  v_mov_b32 v166, 0
  v_mov_b32 v167, 0
  s_mov_b64 exec, -1
  s_waitcnt lgkmcnt(4)
  v_mfma_f32_32x32x16_bf16 v[116:131], v[148:151], v[8:11], v[116:131]
  ds_read_b64_tr_b16 v[148:149], v2 offset:8192
  ds_read_b64_tr_b16 v[150:151], v2 offset:8448
  s_mov_b64 exec, s[48:49]
  v_mov_b32 v160, 0x3f803f80
  v_mov_b32 v161, 0x3f803f80
  v_mov_b32 v162, 0x3f803f80
  v_mov_b32 v163, 0x3f803f80
  v_mov_b32 v164, 0x3f803f80
  v_mov_b32 v165, 0x3f803f80
  v_mov_b32 v166, 0x3f803f80
  v_mov_b32 v167, 0x3f803f80
  s_mov_b64 exec, -1
  s_waitcnt lgkmcnt(4)
  v_mfma_f32_32x32x16_bf16 v[116:131], v[152:155], v[12:15], v[116:131]
  ds_read_b64_tr_b16 v[152:153], v2 offset:10240
  ds_read_b64_tr_b16 v[154:155], v2 offset:10496
  buffer_store_dwordx4 v[160:163], v0, s[40:43], s72 offen sc1
  s_waitcnt lgkmcnt(4)
  v_mfma_f32_32x32x16_bf16 v[116:131], v[156:159], v[16:19], v[116:131]
  ds_read_b64_tr_b16 v[156:157], v2 offset:12288
  ds_read_b64_tr_b16 v[158:159], v2 offset:12544
  v_mul_f32 v132, s69, v132
  v_mul_f32 v133, s69, v133
  v_mul_f32 v134, s69, v134
  s_waitcnt lgkmcnt(4)
  v_mfma_f32_32x32x16_bf16 v[116:131], v[148:151], v[20:23], v[116:131]
  ds_read_b64_tr_b16 v[148:149], v2 offset:14336
  ds_read_b64_tr_b16 v[150:151], v2 offset:14592
  v_add_u32 v2, 98304, v3
  v_mul_f32 v135, s69, v135
  v_mul_f32 v136, s69, v136
  v_mul_f32 v137, s69, v137
  s_waitcnt lgkmcnt(4)
  v_mfma_f32_32x32x16_bf16 v[116:131], v[152:155], v[24:27], v[116:131]
  ds_read_b64_tr_b16 v[152:153], v1 offset:0
  ds_read_b64_tr_b16 v[154:155], v1 offset:256
  v_mul_f32 v138, s69, v138
  v_mul_f32 v139, s69, v139
  v_mul_f32 v140, s69, v140
  s_waitcnt lgkmcnt(4)
  v_mfma_f32_32x32x16_bf16 v[116:131], v[156:159], v[28:31], v[116:131]
  ds_read_b64_tr_b16 v[156:157], v1 offset:2048
  ds_read_b64_tr_b16 v[158:159], v1 offset:2304
  v_mul_f32 v141, s69, v141
  v_mul_f32 v142, s69, v142
  v_mul_f32 v143, s69, v143
  s_waitcnt lgkmcnt(4)
  v_mfma_f32_32x32x16_bf16 v[116:131], v[148:151], v[32:35], v[116:131]
  s_barrier
  ds_read_b64_tr_b16 v[148:149], v1 offset:4096
  ds_read_b64_tr_b16 v[150:151], v1 offset:4352
  buffer_store_dwordx4 v[164:167], v0, s[40:43], s72 offen offset:1024 sc1
  v_mul_f32 v144, s69, v144
  v_mul_f32 v145, s69, v145
  v_mul_f32 v146, s69, v146
  s_waitcnt lgkmcnt(4)
  v_mfma_f32_32x32x16_bf16 v[116:131], v[152:155], v[36:39], v[116:131]
  ds_read_b64_tr_b16 v[152:153], v1 offset:6144
  ds_read_b64_tr_b16 v[154:155], v1 offset:6400
  v_mul_f32 v147, s69, v147
  v_cvt_pk_bf16_f32 v132, v132, v133
  v_cvt_pk_bf16_f32 v133, v134, v135
  v_cvt_pk_bf16_f32 v134, v136, v137
  s_waitcnt lgkmcnt(4)
  v_mfma_f32_32x32x16_bf16 v[116:131], v[156:159], v[40:43], v[116:131]
  ds_read_b64_tr_b16 v[156:157], v1 offset:8192
  ds_read_b64_tr_b16 v[158:159], v1 offset:8448
  v_cvt_pk_bf16_f32 v135, v138, v139
  v_cvt_pk_bf16_f32 v136, v140, v141
  v_cvt_pk_bf16_f32 v137, v142, v143
  s_waitcnt lgkmcnt(4)
  v_mfma_f32_32x32x16_bf16 v[116:131], v[148:151], v[44:47], v[116:131]
  ds_read_b64_tr_b16 v[148:149], v1 offset:10240
  ds_read_b64_tr_b16 v[150:151], v1 offset:10496
  v_cvt_pk_bf16_f32 v138, v144, v145
  v_cvt_pk_bf16_f32 v139, v146, v147
  s_waitcnt lgkmcnt(4)
  v_mfma_f32_32x32x16_bf16 v[116:131], v[152:155], v[48:51], v[116:131]
  ds_read_b64_tr_b16 v[152:153], v1 offset:12288
  ds_read_b64_tr_b16 v[154:155], v1 offset:12544
  s_mov_b64 exec, s[52:53]
  v_mov_b32 v132, 0
  v_mov_b32 v133, 0
  s_mov_b64 exec, s[54:55]
  v_mov_b32 v138, 0
  v_mov_b32 v139, 0
  s_mov_b64 exec, -1
  s_waitcnt lgkmcnt(4)
  v_mfma_f32_32x32x16_bf16 v[116:131], v[156:159], v[52:55], v[116:131]
  ds_read_b64_tr_b16 v[156:157], v1 offset:14336
  ds_read_b64_tr_b16 v[158:159], v1 offset:14592
  v_add_u32 v1, 114688, v3
  s_waitcnt lgkmcnt(4)
  v_mfma_f32_32x32x16_bf16 v[116:131], v[148:151], v[56:59], v[116:131]
  ds_read_b64_tr_b16 v[148:149], v2 offset:0
  ds_read_b64_tr_b16 v[150:151], v2 offset:256
  s_waitcnt lgkmcnt(4)
  v_mfma_f32_32x32x16_bf16 v[116:131], v[152:155], v[60:63], v[116:131]
  ds_read_b64_tr_b16 v[152:153], v2 offset:2048
  ds_read_b64_tr_b16 v[154:155], v2 offset:2304
  buffer_store_dwordx4 v[132:135], v0, s[40:43], s67 offen sc1
  s_waitcnt lgkmcnt(4)
  v_mfma_f32_32x32x16_bf16 v[116:131], v[156:159], v[64:67], v[116:131]
  s_barrier
  ds_read_b64_tr_b16 v[156:157], v2 offset:4096
  ds_read_b64_tr_b16 v[158:159], v2 offset:4352
  s_waitcnt lgkmcnt(4)
  v_mfma_f32_32x32x16_bf16 v[116:131], v[148:151], v[68:71], v[116:131]
  ds_read_b64_tr_b16 v[148:149], v2 offset:6144
  ds_read_b64_tr_b16 v[150:151], v2 offset:6400
  s_waitcnt lgkmcnt(4)
  v_mfma_f32_32x32x16_bf16 v[116:131], v[152:155], v[72:75], v[116:131]
  ds_read_b64_tr_b16 v[152:153], v2 offset:8192
  ds_read_b64_tr_b16 v[154:155], v2 offset:8448
  s_waitcnt lgkmcnt(4)
  v_mfma_f32_32x32x16_bf16 v[116:131], v[156:159], v[76:79], v[116:131]
  ds_read_b64_tr_b16 v[156:157], v2 offset:10240
  ds_read_b64_tr_b16 v[158:159], v2 offset:10496
  s_waitcnt lgkmcnt(4)
  v_mfma_f32_32x32x16_bf16 v[116:131], v[148:151], v[80:83], v[116:131]
  ds_read_b64_tr_b16 v[148:149], v2 offset:12288
  ds_read_b64_tr_b16 v[150:151], v2 offset:12544
  s_waitcnt lgkmcnt(4)
  v_mfma_f32_32x32x16_bf16 v[116:131], v[152:155], v[84:87], v[116:131]
  ds_read_b64_tr_b16 v[152:153], v2 offset:14336
  ds_read_b64_tr_b16 v[154:155], v2 offset:14592
  v_add_u32 v2, 131072, v3
  s_waitcnt lgkmcnt(4)
  v_mfma_f32_32x32x16_bf16 v[116:131], v[156:159], v[88:91], v[116:131]
  ds_read_b64_tr_b16 v[156:157], v1 offset:0
  ds_read_b64_tr_b16 v[158:159], v1 offset:256
  buffer_store_dwordx4 v[136:139], v0, s[40:43], s67 offen offset:1024 sc1
  s_waitcnt lgkmcnt(4)
  v_mfma_f32_32x32x16_bf16 v[116:131], v[148:151], v[92:95], v[116:131]
  ds_read_b64_tr_b16 v[148:149], v1 offset:2048
  ds_read_b64_tr_b16 v[150:151], v1 offset:2304
  s_waitcnt lgkmcnt(4)
  v_mfma_f32_32x32x16_bf16 v[116:131], v[152:155], v[96:99], v[116:131]
  s_barrier
  ds_read_b64_tr_b16 v[152:153], v1 offset:4096
  ds_read_b64_tr_b16 v[154:155], v1 offset:4352
  s_waitcnt lgkmcnt(4)
  v_mfma_f32_32x32x16_bf16 v[116:131], v[156:159], v[100:103], v[116:131]
  ds_read_b64_tr_b16 v[156:157], v1 offset:6144
  ds_read_b64_tr_b16 v[158:159], v1 offset:6400
  v_add_u32 v1, 147456, v3
  s_waitcnt lgkmcnt(4)
  v_mfma_f32_32x32x16_bf16 v[116:131], v[148:151], v[104:107], v[116:131]
  ds_read_b64_tr_b16 v[148:149], v2 offset:0
  ds_read_b64_tr_b16 v[150:151], v2 offset:256
  s_waitcnt lgkmcnt(4)
  v_mfma_f32_32x32x16_bf16 v[116:131], v[152:155], v[108:111], v[116:131]
  ds_read_b64_tr_b16 v[152:153], v2 offset:2048
  ds_read_b64_tr_b16 v[154:155], v2 offset:2304
  s_waitcnt lgkmcnt(4)
  v_mfma_f32_32x32x16_bf16 v[116:131], v[156:159], v[112:115], v[116:131]
  s_waitcnt vmcnt(0)
  s_barrier
  ds_read_b64_tr_b16 v[156:157], v2 offset:4096
  ds_read_b64_tr_b16 v[158:159], v2 offset:4352
  s_waitcnt lgkmcnt(4)
  v_mfma_f32_32x32x16_bf16 v[132:147], v[148:151], v[4:7], 0
  ds_read_b64_tr_b16 v[148:149], v2 offset:6144
  ds_read_b64_tr_b16 v[150:151], v2 offset:6400
  s_waitcnt lgkmcnt(4)
  v_mfma_f32_32x32x16_bf16 v[132:147], v[152:155], v[8:11], v[132:147]
  ds_read_b64_tr_b16 v[152:153], v2 offset:8192
  ds_read_b64_tr_b16 v[154:155], v2 offset:8448
  s_waitcnt lgkmcnt(4)
  v_mfma_f32_32x32x16_bf16 v[132:147], v[156:159], v[12:15], v[132:147]
  ds_read_b64_tr_b16 v[156:157], v2 offset:10240
  ds_read_b64_tr_b16 v[158:159], v2 offset:10496
  v_mul_f32 v160, s64, v116
  v_mul_f32 v161, s64, v117
  v_mul_f32 v162, s64, v118
  v_mul_f32 v163, s64, v119
  v_fma_f32 v164, v160, v160, s65
  v_fma_f32 v165, v161, v161, s65
  s_waitcnt lgkmcnt(4)
  v_mfma_f32_32x32x16_bf16 v[132:147], v[148:151], v[16:19], v[132:147]
  ds_read_b64_tr_b16 v[148:149], v2 offset:12288
  ds_read_b64_tr_b16 v[150:151], v2 offset:12544
  v_fma_f32 v166, v162, v162, s65
  v_fma_f32 v167, v163, v163, s65
  v_mul_f32 v160, v160, v164
  v_mul_f32 v161, v161, v165
  v_mul_f32 v162, v162, v166
  v_mul_f32 v163, v163, v167
  s_waitcnt lgkmcnt(4)
  v_mfma_f32_32x32x16_bf16 v[132:147], v[152:155], v[20:23], v[132:147]
  ds_read_b64_tr_b16 v[152:153], v2 offset:14336
  ds_read_b64_tr_b16 v[154:155], v2 offset:14592
  v_add_u32 v2, 0, v3
  v_exp_f32 v160, v160
  v_exp_f32 v161, v161
  v_exp_f32 v162, v162
  s_waitcnt lgkmcnt(4)
  v_mfma_f32_32x32x16_bf16 v[132:147], v[156:159], v[24:27], v[132:147]
  ds_read_b64_tr_b16 v[156:157], v1 offset:0
  ds_read_b64_tr_b16 v[158:159], v1 offset:256
  v_exp_f32 v163, v163
  v_add_f32 v160, 1.0, v160
  v_add_f32 v161, 1.0, v161
  v_add_f32 v162, 1.0, v162
  s_waitcnt lgkmcnt(4)
  v_mfma_f32_32x32x16_bf16 v[132:147], v[148:151], v[28:31], v[132:147]
  ds_read_b64_tr_b16 v[148:149], v1 offset:2048
  ds_read_b64_tr_b16 v[150:151], v1 offset:2304
  v_add_f32 v163, 1.0, v163
  v_rcp_f32 v160, v160
  v_rcp_f32 v161, v161
  s_waitcnt lgkmcnt(4)
  v_mfma_f32_32x32x16_bf16 v[132:147], v[152:155], v[32:35], v[132:147]
  s_barrier
  ds_read_b64_tr_b16 v[152:153], v1 offset:4096
  ds_read_b64_tr_b16 v[154:155], v1 offset:4352
  v_rcp_f32 v162, v162
  v_rcp_f32 v163, v163
  v_mul_f32 v116, v116, v160
  v_mul_f32 v117, v117, v161
  v_mul_f32 v118, v118, v162
  s_waitcnt lgkmcnt(4)
  v_mfma_f32_32x32x16_bf16 v[132:147], v[156:159], v[36:39], v[132:147]
  ds_read_b64_tr_b16 v[156:157], v1 offset:6144
  ds_read_b64_tr_b16 v[158:159], v1 offset:6400
  v_mul_f32 v119, v119, v163
  v_mul_f32 v160, s64, v120
  v_mul_f32 v161, s64, v121
  v_mul_f32 v162, s64, v122
  v_mul_f32 v163, s64, v123
  s_waitcnt lgkmcnt(4)
  v_mfma_f32_32x32x16_bf16 v[132:147], v[148:151], v[40:43], v[132:147]
  ds_read_b64_tr_b16 v[148:149], v1 offset:8192
  ds_read_b64_tr_b16 v[150:151], v1 offset:8448
  v_fma_f32 v164, v160, v160, s65
  v_fma_f32 v165, v161, v161, s65
  v_fma_f32 v166, v162, v162, s65
  v_fma_f32 v167, v163, v163, s65
  v_mul_f32 v160, v160, v164
  v_mul_f32 v161, v161, v165
  s_waitcnt lgkmcnt(4)
  v_mfma_f32_32x32x16_bf16 v[132:147], v[152:155], v[44:47], v[132:147]
  ds_read_b64_tr_b16 v[152:153], v1 offset:10240
  ds_read_b64_tr_b16 v[154:155], v1 offset:10496
  v_mul_f32 v162, v162, v166
  v_mul_f32 v163, v163, v167
  v_exp_f32 v160, v160
  v_exp_f32 v161, v161
  s_waitcnt lgkmcnt(4)
  v_mfma_f32_32x32x16_bf16 v[132:147], v[156:159], v[48:51], v[132:147]
  ds_read_b64_tr_b16 v[156:157], v1 offset:12288
  ds_read_b64_tr_b16 v[158:159], v1 offset:12544
  v_exp_f32 v162, v162
  v_exp_f32 v163, v163
  v_add_f32 v160, 1.0, v160
  v_add_f32 v161, 1.0, v161
  s_waitcnt lgkmcnt(4)
  v_mfma_f32_32x32x16_bf16 v[132:147], v[148:151], v[52:55], v[132:147]
  ds_read_b64_tr_b16 v[148:149], v1 offset:14336
  ds_read_b64_tr_b16 v[150:151], v1 offset:14592
  v_add_u32 v1, 16384, v3
  v_add_f32 v162, 1.0, v162
  v_add_f32 v163, 1.0, v163
  v_rcp_f32 v160, v160
  v_rcp_f32 v161, v161
  s_waitcnt lgkmcnt(4)
  v_mfma_f32_32x32x16_bf16 v[132:147], v[152:155], v[56:59], v[132:147]
  ds_read_b64_tr_b16 v[152:153], v2 offset:0
  ds_read_b64_tr_b16 v[154:155], v2 offset:256
  v_rcp_f32 v162, v162
  v_rcp_f32 v163, v163
  v_mul_f32 v120, v120, v160
  s_waitcnt lgkmcnt(4)
  v_mfma_f32_32x32x16_bf16 v[132:147], v[156:159], v[60:63], v[132:147]
  ds_read_b64_tr_b16 v[156:157], v2 offset:2048
  ds_read_b64_tr_b16 v[158:159], v2 offset:2304
  v_mul_f32 v121, v121, v161
  v_mul_f32 v122, v122, v162
  v_mul_f32 v123, v123, v163
  v_mul_f32 v160, s64, v124
  v_mul_f32 v161, s64, v125
  v_mul_f32 v162, s64, v126
  s_waitcnt lgkmcnt(4)
  v_mfma_f32_32x32x16_bf16 v[132:147], v[148:151], v[64:67], v[132:147]
  s_barrier
  ds_read_b64_tr_b16 v[148:149], v2 offset:4096
  ds_read_b64_tr_b16 v[150:151], v2 offset:4352
  v_mul_f32 v163, s64, v127
  v_fma_f32 v164, v160, v160, s65
  v_fma_f32 v165, v161, v161, s65
  v_fma_f32 v166, v162, v162, s65
  v_fma_f32 v167, v163, v163, s65
  v_mul_f32 v160, v160, v164
  s_waitcnt lgkmcnt(4)
  v_mfma_f32_32x32x16_bf16 v[132:147], v[152:155], v[68:71], v[132:147]
  ds_read_b64_tr_b16 v[152:153], v2 offset:6144
  ds_read_b64_tr_b16 v[154:155], v2 offset:6400
  v_mul_f32 v161, v161, v165
  v_mul_f32 v162, v162, v166
  v_mul_f32 v163, v163, v167
  v_exp_f32 v160, v160
  s_waitcnt lgkmcnt(4)
  v_mfma_f32_32x32x16_bf16 v[132:147], v[156:159], v[72:75], v[132:147]
  ds_read_b64_tr_b16 v[156:157], v2 offset:8192
  ds_read_b64_tr_b16 v[158:159], v2 offset:8448
  v_exp_f32 v161, v161
  v_exp_f32 v162, v162
  v_exp_f32 v163, v163
  s_waitcnt lgkmcnt(4)
  v_mfma_f32_32x32x16_bf16 v[132:147], v[148:151], v[76:79], v[132:147]
  ds_read_b64_tr_b16 v[148:149], v2 offset:10240
  ds_read_b64_tr_b16 v[150:151], v2 offset:10496
  v_add_f32 v160, 1.0, v160
  v_add_f32 v161, 1.0, v161
  v_add_f32 v162, 1.0, v162
  v_add_f32 v163, 1.0, v163
  v_rcp_f32 v160, v160
  s_waitcnt lgkmcnt(4)
  v_mfma_f32_32x32x16_bf16 v[132:147], v[152:155], v[80:83], v[132:147]
  ds_read_b64_tr_b16 v[152:153], v2 offset:12288
  ds_read_b64_tr_b16 v[154:155], v2 offset:12544
  v_rcp_f32 v161, v161
  v_rcp_f32 v162, v162
  v_rcp_f32 v163, v163
  s_waitcnt lgkmcnt(4)
  v_mfma_f32_32x32x16_bf16 v[132:147], v[156:159], v[84:87], v[132:147]
  ds_read_b64_tr_b16 v[156:157], v2 offset:14336
  ds_read_b64_tr_b16 v[158:159], v2 offset:14592
  v_bfe_u32 v2, v3, 10, 1
  v_lshlrev_b32 v2, 9, v2
  v_and_b32 v3, 255, v3
  v_or_b32 v2, v2, v3
  v_bfe_u32 v3, v3, 5, 1
  v_mul_u32_u24 v3, 992, v3
  s_lshl_b32 s12, s61, 5
  v_add3_u32 v3, v3, v2, s12
  v_add_u32 v2, 32768, v3
  v_mul_f32 v124, v124, v160
  v_mul_f32 v125, v125, v161
  v_mul_f32 v126, v126, v162
  v_mul_f32 v127, v127, v163
  v_mul_f32 v160, s64, v128
  s_waitcnt lgkmcnt(4)
  v_mfma_f32_32x32x16_bf16 v[132:147], v[148:151], v[88:91], v[132:147]
  ds_read_b64_tr_b16 v[148:149], v1 offset:0
  ds_read_b64_tr_b16 v[150:151], v1 offset:256
  v_mul_f32 v161, s64, v129
  v_mul_f32 v162, s64, v130
  v_mul_f32 v163, s64, v131
  v_fma_f32 v164, v160, v160, s65
  v_fma_f32 v165, v161, v161, s65
  v_fma_f32 v166, v162, v162, s65
  s_waitcnt lgkmcnt(4)
  v_mfma_f32_32x32x16_bf16 v[132:147], v[152:155], v[92:95], v[132:147]
  ds_read_b64_tr_b16 v[152:153], v1 offset:2048
  ds_read_b64_tr_b16 v[154:155], v1 offset:2304
  v_fma_f32 v167, v163, v163, s65
  v_mul_f32 v160, v160, v164
  v_mul_f32 v161, v161, v165
  v_mul_f32 v162, v162, v166
  v_mul_f32 v163, v163, v167
  s_waitcnt lgkmcnt(4)
  v_mfma_f32_32x32x16_bf16 v[132:147], v[156:159], v[96:99], v[132:147]
  s_barrier
  ds_read_b64_tr_b16 v[156:157], v1 offset:4096
  ds_read_b64_tr_b16 v[158:159], v1 offset:4352
  v_exp_f32 v160, v160
  v_exp_f32 v161, v161
  v_exp_f32 v162, v162
  s_waitcnt lgkmcnt(4)
  v_mfma_f32_32x32x16_bf16 v[132:147], v[148:151], v[100:103], v[132:147]
  ds_read_b64_tr_b16 v[148:149], v1 offset:6144
  ds_read_b64_tr_b16 v[150:151], v1 offset:6400
  v_add_u32 v1, 49152, v3
  v_exp_f32 v163, v163
  v_add_f32 v160, 1.0, v160
  v_add_f32 v161, 1.0, v161
  v_add_f32 v162, 1.0, v162
  v_add_f32 v163, 1.0, v163
  s_waitcnt lgkmcnt(4)
  v_mfma_f32_32x32x16_bf16 v[132:147], v[152:155], v[104:107], v[132:147]
  ds_read_b64_tr_b16 v[152:153], v2 offset:0
  ds_read_b64_tr_b16 v[154:155], v2 offset:256
  v_rcp_f32 v160, v160
  v_rcp_f32 v161, v161
  v_rcp_f32 v162, v162
  s_waitcnt lgkmcnt(4)
  v_mfma_f32_32x32x16_bf16 v[132:147], v[156:159], v[108:111], v[132:147]
  ds_read_b64_tr_b16 v[156:157], v2 offset:2048
  ds_read_b64_tr_b16 v[158:159], v2 offset:2304
  v_rcp_f32 v163, v163
  v_mul_f32 v128, v128, v160
  v_mul_f32 v129, v129, v161
  v_mul_f32 v130, v130, v162
  v_mul_f32 v131, v131, v163
  s_waitcnt lgkmcnt(4)
  v_mfma_f32_32x32x16_bf16 v[132:147], v[148:151], v[112:115], v[132:147]
  s_barrier
  ds_read_b64_tr_b16 v[148:149], v2 offset:4096
  ds_read_b64_tr_b16 v[150:151], v2 offset:4352
  s_nop 8
  v_mul_f32 v132, v132, v116
  v_mul_f32 v133, v133, v117
  v_mul_f32 v134, v134, v118
  v_mul_f32 v135, v135, v119
  v_mul_f32 v136, v136, v120
  v_mul_f32 v137, v137, v121
  v_mul_f32 v138, v138, v122
  v_mul_f32 v139, v139, v123
  v_mul_f32 v140, v140, v124
  v_mul_f32 v141, v141, v125
  v_mul_f32 v142, v142, v126
  v_mul_f32 v143, v143, v127
  v_mul_f32 v144, v144, v128
  v_mul_f32 v145, v145, v129
  v_mul_f32 v146, v146, v130
  v_mul_f32 v147, v147, v131
  s_waitcnt lgkmcnt(4)
  v_mfma_f32_32x32x16_bf16 v[116:131], v[152:155], v[4:7], 0
  ds_read_b64_tr_b16 v[152:153], v2 offset:6144
  ds_read_b64_tr_b16 v[154:155], v2 offset:6400
  s_waitcnt lgkmcnt(4)
  v_mfma_f32_32x32x16_bf16 v[116:131], v[156:159], v[8:11], v[116:131]
  ds_read_b64_tr_b16 v[156:157], v2 offset:8192
  ds_read_b64_tr_b16 v[158:159], v2 offset:8448
  v_cvt_pk_bf16_f32 v132, v132, v133
  v_cvt_pk_bf16_f32 v133, v134, v135
  v_cvt_pk_bf16_f32 v134, v136, v137
  s_waitcnt lgkmcnt(4)
  v_mfma_f32_32x32x16_bf16 v[116:131], v[148:151], v[12:15], v[116:131]
  ds_read_b64_tr_b16 v[148:149], v2 offset:10240
  ds_read_b64_tr_b16 v[150:151], v2 offset:10496
  v_cvt_pk_bf16_f32 v135, v138, v139
  v_cvt_pk_bf16_f32 v136, v140, v141
  v_cvt_pk_bf16_f32 v137, v142, v143
  s_waitcnt lgkmcnt(4)
  v_mfma_f32_32x32x16_bf16 v[116:131], v[152:155], v[16:19], v[116:131]
  ds_read_b64_tr_b16 v[152:153], v2 offset:12288
  ds_read_b64_tr_b16 v[154:155], v2 offset:12544
  v_cvt_pk_bf16_f32 v138, v144, v145
  v_cvt_pk_bf16_f32 v139, v146, v147
  s_waitcnt lgkmcnt(4)
  v_mfma_f32_32x32x16_bf16 v[116:131], v[156:159], v[20:23], v[116:131]
  ds_read_b64_tr_b16 v[156:157], v2 offset:14336
  ds_read_b64_tr_b16 v[158:159], v2 offset:14592
  v_add_u32 v2, 65536, v3
  buffer_store_dwordx4 v[132:135], v0, s[40:43], s70 offen sc1
  s_waitcnt lgkmcnt(4)
  v_mfma_f32_32x32x16_bf16 v[116:131], v[148:151], v[24:27], v[116:131]
  ds_read_b64_tr_b16 v[148:149], v1 offset:0
  ds_read_b64_tr_b16 v[150:151], v1 offset:256
  buffer_store_dwordx4 v[136:139], v0, s[40:43], s70 offen offset:1024 sc1
  s_waitcnt lgkmcnt(4)
  v_mfma_f32_32x32x16_bf16 v[116:131], v[152:155], v[28:31], v[116:131]
  ds_read_b64_tr_b16 v[152:153], v1 offset:2048
  ds_read_b64_tr_b16 v[154:155], v1 offset:2304
  s_add_u32 s70, s70, 4096
  s_waitcnt lgkmcnt(4)
  v_mfma_f32_32x32x16_bf16 v[116:131], v[156:159], v[32:35], v[116:131]
  s_barrier
  ds_read_b64_tr_b16 v[156:157], v1 offset:4096
  ds_read_b64_tr_b16 v[158:159], v1 offset:4352
  s_waitcnt lgkmcnt(4)
  v_mfma_f32_32x32x16_bf16 v[116:131], v[148:151], v[36:39], v[116:131]
  ds_read_b64_tr_b16 v[148:149], v1 offset:6144
  ds_read_b64_tr_b16 v[150:151], v1 offset:6400
  s_lshr_b32 s7, s6, 4
  s_lshl_b32 s8, s5, 1
  s_add_u32 s7, s7, s8
  s_and_b32 s8, s6, 15
  s_waitcnt lgkmcnt(4)
  v_mfma_f32_32x32x16_bf16 v[116:131], v[152:155], v[40:43], v[116:131]
  ds_read_b64_tr_b16 v[152:153], v1 offset:8192
  ds_read_b64_tr_b16 v[154:155], v1 offset:8448
  s_lshl_b32 s11, s8, 2
  s_add_u32 s11, s11, s60
  s_lshl_b32 s9, s7, 18
  s_add_u32 s9, s9, 2097152
  s_waitcnt lgkmcnt(4)
  v_mfma_f32_32x32x16_bf16 v[116:131], v[156:159], v[44:47], v[116:131]
  ds_read_b64_tr_b16 v[156:157], v1 offset:10240
  ds_read_b64_tr_b16 v[158:159], v1 offset:10496
  s_lshl_b32 s46, s61, 14
  s_add_u32 s47, s46, 65536
  s_lshl_b32 s13, s60, 12
  s_waitcnt lgkmcnt(4)
  v_mfma_f32_32x32x16_bf16 v[116:131], v[148:151], v[48:51], v[116:131]
  ds_read_b64_tr_b16 v[148:149], v1 offset:12288
  ds_read_b64_tr_b16 v[150:151], v1 offset:12544
  s_add_u32 s14, s46, 65536
  s_lshl_b32 s15, s61, 7
  s_add_u32 s15, s15, 113664
  s_mov_b32 s48, 1
  s_waitcnt lgkmcnt(4)
  v_mfma_f32_32x32x16_bf16 v[116:131], v[152:155], v[52:55], v[116:131]
  ds_read_b64_tr_b16 v[152:153], v1 offset:14336
  ds_read_b64_tr_b16 v[154:155], v1 offset:14592
  v_add_u32 v1, 81920, v3
  s_mov_b32 s49, 0
  s_mov_b32 s50, 4
  s_mov_b32 s51, 4
  s_lshl_b32 s10, s60, 11
  s_waitcnt lgkmcnt(4)
  v_mfma_f32_32x32x16_bf16 v[116:131], v[156:159], v[56:59], v[116:131]
  ds_read_b64_tr_b16 v[156:157], v2 offset:0
  ds_read_b64_tr_b16 v[158:159], v2 offset:256
  s_add_u32 s10, s10, 90112
  s_add_u32 s36, s34, s9
  s_addc_u32 s37, s35, 0
  s_mov_b32 s38, 262144
  s_waitcnt lgkmcnt(4)
  v_mfma_f32_32x32x16_bf16 v[116:131], v[148:151], v[60:63], v[116:131]
  ds_read_b64_tr_b16 v[148:149], v2 offset:2048
  ds_read_b64_tr_b16 v[150:151], v2 offset:2304
  s_waitcnt lgkmcnt(4)
  v_mfma_f32_32x32x16_bf16 v[116:131], v[152:155], v[64:67], v[116:131]
  s_barrier
  ds_read_b64_tr_b16 v[152:153], v2 offset:4096
  ds_read_b64_tr_b16 v[154:155], v2 offset:4352
  s_waitcnt lgkmcnt(4)
  v_mfma_f32_32x32x16_bf16 v[116:131], v[156:159], v[68:71], v[116:131]
  ds_read_b64_tr_b16 v[156:157], v2 offset:6144
  ds_read_b64_tr_b16 v[158:159], v2 offset:6400
  s_waitcnt lgkmcnt(4)
  v_mfma_f32_32x32x16_bf16 v[116:131], v[148:151], v[72:75], v[116:131]
  ds_read_b64_tr_b16 v[148:149], v2 offset:8192
  ds_read_b64_tr_b16 v[150:151], v2 offset:8448
  s_waitcnt lgkmcnt(4)
  v_mfma_f32_32x32x16_bf16 v[116:131], v[152:155], v[76:79], v[116:131]
  ds_read_b64_tr_b16 v[152:153], v2 offset:10240
  ds_read_b64_tr_b16 v[154:155], v2 offset:10496
  s_waitcnt lgkmcnt(4)
  v_mfma_f32_32x32x16_bf16 v[116:131], v[156:159], v[80:83], v[116:131]
  ds_read_b64_tr_b16 v[156:157], v2 offset:12288
  ds_read_b64_tr_b16 v[158:159], v2 offset:12544
  s_waitcnt lgkmcnt(4)
  v_mfma_f32_32x32x16_bf16 v[116:131], v[148:151], v[84:87], v[116:131]
  ds_read_b64_tr_b16 v[148:149], v2 offset:14336
  ds_read_b64_tr_b16 v[150:151], v2 offset:14592
  s_waitcnt lgkmcnt(4)
  v_mfma_f32_32x32x16_bf16 v[116:131], v[152:155], v[88:91], v[116:131]
  ds_read_b64_tr_b16 v[152:153], v1 offset:0
  ds_read_b64_tr_b16 v[154:155], v1 offset:256
  s_waitcnt lgkmcnt(4)
  v_mfma_f32_32x32x16_bf16 v[116:131], v[156:159], v[92:95], v[116:131]
  ds_read_b64_tr_b16 v[156:157], v1 offset:2048
  ds_read_b64_tr_b16 v[158:159], v1 offset:2304
  s_waitcnt lgkmcnt(4)
  v_mfma_f32_32x32x16_bf16 v[116:131], v[148:151], v[96:99], v[116:131]
  s_barrier
  ds_read_b64_tr_b16 v[148:149], v1 offset:4096
  ds_read_b64_tr_b16 v[150:151], v1 offset:4352
  s_waitcnt lgkmcnt(4)
  v_mfma_f32_32x32x16_bf16 v[116:131], v[152:155], v[100:103], v[116:131]
  ds_read_b64_tr_b16 v[152:153], v1 offset:6144
  ds_read_b64_tr_b16 v[154:155], v1 offset:6400
  s_waitcnt lgkmcnt(4)
  v_mfma_f32_32x32x16_bf16 v[116:131], v[156:159], v[104:107], v[116:131]
  s_waitcnt lgkmcnt(2)
  v_mfma_f32_32x32x16_bf16 v[116:131], v[148:151], v[108:111], v[116:131]
  s_waitcnt lgkmcnt(0)
  v_mfma_f32_32x32x16_bf16 v[116:131], v[152:155], v[112:115], v[116:131]
  v_mov_b32 v92, 113760
  v_add_u32 v94, s10, v0
  v_add_u32 v1, s46, v0
  v_add_u32 v2, 32768, v1
  s_mov_b32 s52, 32768
L_w0a:
  ds_read_b32 v90, v92
  s_sub_u32 s52, s52, 1
  s_waitcnt lgkmcnt(0)
  v_cmp_ne_u32 vcc, 4, v90
  s_cmp_eq_u32 s52, 0
  s_cbranch_scc1 L_w0a_x
  s_cmp_eq_u64 vcc, 0
  s_cbranch_scc1 L_w0a_x
  s_sleep 1
  s_branch L_w0a
L_w0a_x:
  ds_read_b128 v[8:11], v94
  ds_read_b128 v[12:15], v94 offset:1024
  ds_read_b128 v[16:19], v1
  ds_read_b128 v[20:23], v1 offset:1024
  ds_read_b64 v[100:101], v92 offset:8
  v_add_u32 v5, s13, v0
  v_mov_b32 v6, s15
  v_xor_b32 v4, 128, v6
  v_mov_b32 v88, 1
  v_mov_b32 v89, 0
  s_waitcnt lgkmcnt(0)
  v_mfma_f32_32x32x16_bf16 v[32:47], v[16:19], v[8:11], 0
  v_mfma_f32_32x32x16_bf16 v[32:47], v[20:23], v[12:15], v[32:47]
  ds_read_b128 v[16:19], v1 offset:4096
  ds_read_b128 v[20:23], v1 offset:5120
  ds_read_b128 v[28:31], v1 offset:3072
  ds_read_b128 v[24:27], v1 offset:2048
  v_mul_f32 v160, s64, v116
  v_mul_f32 v161, s64, v117
  v_mul_f32 v162, s64, v118
  v_mul_f32 v163, s64, v119
  v_fma_f32 v164, v160, v160, s65
  v_fma_f32 v165, v161, v161, s65
  v_fma_f32 v166, v162, v162, s65
  v_fma_f32 v167, v163, v163, s65
  v_mul_f32 v160, v160, v164
  v_mul_f32 v161, v161, v165
  v_mul_f32 v162, v162, v166
  v_mul_f32 v163, v163, v167
  s_waitcnt lgkmcnt(2)
  v_mfma_f32_32x32x16_bf16 v[48:63], v[16:19], v[8:11], 0
  ds_read_b128 v[16:19], v1 offset:8192
  v_exp_f32 v32, v32
  v_exp_f32 v33, v33
  s_waitcnt vmcnt(0)
  s_barrier
  v_exp_f32 v160, v160
  v_exp_f32 v161, v161
  v_exp_f32 v162, v162
  v_exp_f32 v163, v163
  v_add_f32 v160, 1.0, v160
  v_add_f32 v161, 1.0, v161
  v_add_f32 v162, 1.0, v162
  v_add_f32 v163, 1.0, v163
  v_rcp_f32 v160, v160
  v_rcp_f32 v161, v161
  v_rcp_f32 v162, v162
  v_exp_f32 v34, v34
  v_exp_f32 v35, v35
  v_mfma_f32_32x32x16_bf16 v[48:63], v[20:23], v[12:15], v[48:63]
  ds_read_b128 v[20:23], v1 offset:9216
  v_exp_f32 v36, v36
  v_cvt_pk_bf16_f32 v64, v32, v33
  v_exp_f32 v37, v37
  v_cvt_pk_bf16_f32 v65, v34, v35
  v_rcp_f32 v163, v163
  v_mul_f32 v116, v116, v160
  v_mul_f32 v117, v117, v161
  v_mul_f32 v118, v118, v162
  v_mul_f32 v119, v119, v163
  v_mul_f32 v160, s64, v120
  v_mul_f32 v161, s64, v121
  v_mul_f32 v162, s64, v122
  v_mul_f32 v163, s64, v123
  v_fma_f32 v164, v160, v160, s65
  v_fma_f32 v165, v161, v161, s65
  v_exp_f32 v38, v38
  v_exp_f32 v39, v39
  s_waitcnt lgkmcnt(2)
  ds_read_b128 v[28:31], v1 offset:3072
  v_exp_f32 v40, v40
  v_cvt_pk_bf16_f32 v66, v36, v37
  v_exp_f32 v41, v41
  v_cvt_pk_bf16_f32 v67, v38, v39
  v_fma_f32 v166, v162, v162, s65
  v_fma_f32 v167, v163, v163, s65
  v_mul_f32 v160, v160, v164
  v_mul_f32 v161, v161, v165
  v_mul_f32 v162, v162, v166
  v_mul_f32 v163, v163, v167
  v_exp_f32 v160, v160
  v_exp_f32 v161, v161
  v_exp_f32 v162, v162
  v_exp_f32 v163, v163
  v_add_f32 v160, 1.0, v160
  v_add_f32 v161, 1.0, v161
  v_exp_f32 v42, v42
  v_exp_f32 v43, v43
  v_mfma_f32_32x32x16_bf16 v[72:87], v[24:27], v[64:67], 0
  ds_read_b128 v[24:27], v1 offset:6144
  v_exp_f32 v96, v44
  v_cvt_pk_bf16_f32 v68, v40, v41
  v_exp_f32 v97, v45
  v_cvt_pk_bf16_f32 v69, v42, v43
  s_mov_b64 exec, 1
  ds_add_u64 v6, v[88:89]
  s_mov_b64 exec, -1
  v_add_f32 v162, 1.0, v162
  v_add_f32 v163, 1.0, v163
  v_rcp_f32 v160, v160
  v_rcp_f32 v161, v161
  v_rcp_f32 v162, v162
  v_rcp_f32 v163, v163
  v_mul_f32 v120, v120, v160
  v_mul_f32 v121, v121, v161
  v_mul_f32 v122, v122, v162
  v_mul_f32 v123, v123, v163
  v_mul_f32 v116, v116, v124
  v_exp_f32 v98, v46
  v_exp_f32 v99, v47
  s_waitcnt lgkmcnt(2)
  v_mfma_f32_32x32x16_bf16 v[32:47], v[16:19], v[8:11], 0
  ds_read_b128 v[16:19], v1 offset:12288
  v_exp_f32 v48, v48
  v_cvt_pk_bf16_f32 v70, v96, v97
  v_exp_f32 v49, v49
  v_cvt_pk_bf16_f32 v71, v98, v99
  v_mul_f32 v117, v117, v125
  v_mul_f32 v118, v118, v126
  v_mul_f32 v119, v119, v127
  v_mul_f32 v120, v120, v128
  v_mul_f32 v121, v121, v129
  v_mul_f32 v122, v122, v130
  v_mul_f32 v123, v123, v131
  v_cvt_pk_bf16_f32 v116, v116, v117
  v_cvt_pk_bf16_f32 v117, v118, v119
  v_cvt_pk_bf16_f32 v118, v120, v121
  v_cvt_pk_bf16_f32 v119, v122, v123
  buffer_store_dwordx4 v[116:119], v0, s[40:43], s71 offen sc1
  v_exp_f32 v50, v50
  v_exp_f32 v51, v51
  v_mfma_f32_32x32x16_bf16 v[32:47], v[20:23], v[12:15], v[32:47]
  ds_read_b128 v[20:23], v1 offset:13312
  v_exp_f32 v52, v52
  v_cvt_pk_bf16_f32 v64, v48, v49
  v_exp_f32 v53, v53
  v_cvt_pk_bf16_f32 v65, v50, v51
  v_exp_f32 v54, v54
  v_exp_f32 v55, v55
  s_waitcnt lgkmcnt(2)
  v_mfma_f32_32x32x16_bf16 v[72:87], v[28:31], v[68:71], v[72:87]
  ds_read_b128 v[28:31], v1 offset:7168
  v_exp_f32 v56, v56
  v_cvt_pk_bf16_f32 v66, v52, v53
  v_exp_f32 v57, v57
  v_cvt_pk_bf16_f32 v67, v54, v55
  ds_read_b64 v[90:91], v6
  ds_read_b32 v92, v4
  v_exp_f32 v58, v58
  v_exp_f32 v59, v59
  v_mfma_f32_32x32x16_bf16 v[72:87], v[24:27], v[64:67], v[72:87]
  ds_read_b128 v[24:27], v1 offset:10240
  v_exp_f32 v96, v60
  v_cvt_pk_bf16_f32 v68, v56, v57
  v_exp_f32 v97, v61
  v_cvt_pk_bf16_f32 v69, v58, v59
  v_exp_f32 v98, v62
  v_exp_f32 v99, v63
  s_waitcnt lgkmcnt(1)
  v_cmp_ne_u64 vcc, s[50:51], v[90:91]
  s_add_u32 m0, s47, s13
  s_cmp_lg_u64 vcc, 0
  s_cbranch_scc1 L_a_spinfa
L_a_gofa:
  v_cmp_eq_u32 vcc, 4, v92
  s_setprio 0
  s_cmp_eq_u64 vcc, 0
  s_cbranch_scc1 L_a_prfa
  s_setprio 1
L_a_prfa:
  buffer_load_dwordx4 v5, s[36:39], s14 offen offset:0 sc1 lds
  buffer_load_dwordx4 v5, s[36:39], s14 offen offset:1024 sc1 lds
  buffer_load_dwordx4 v5, s[36:39], s14 offen offset:2048 sc1 lds
  buffer_load_dwordx4 v5, s[36:39], s14 offen offset:3072 sc1 lds
  s_add_u32 s14, s14, 32768
  s_waitcnt lgkmcnt(2)
  v_mfma_f32_32x32x16_bf16 v[48:63], v[16:19], v[8:11], 0
  ds_read_b128 v[16:19], v2 offset:0
  v_exp_f32 v32, v32
  v_cvt_pk_bf16_f32 v70, v96, v97
  v_exp_f32 v33, v33
  v_cvt_pk_bf16_f32 v71, v98, v99
  v_exp_f32 v34, v34
  v_exp_f32 v35, v35
  v_mfma_f32_32x32x16_bf16 v[48:63], v[20:23], v[12:15], v[48:63]
  ds_read_b128 v[20:23], v2 offset:1024
  v_exp_f32 v36, v36
  v_cvt_pk_bf16_f32 v64, v32, v33
  v_exp_f32 v37, v37
  v_cvt_pk_bf16_f32 v65, v34, v35
  v_exp_f32 v38, v38
  v_exp_f32 v39, v39
  s_waitcnt lgkmcnt(2)
  v_mfma_f32_32x32x16_bf16 v[72:87], v[28:31], v[68:71], v[72:87]
  ds_read_b128 v[28:31], v1 offset:11264
  v_exp_f32 v40, v40
  v_cvt_pk_bf16_f32 v66, v36, v37
  v_exp_f32 v41, v41
  v_cvt_pk_bf16_f32 v67, v38, v39
  v_exp_f32 v42, v42
  v_exp_f32 v43, v43
  v_mfma_f32_32x32x16_bf16 v[72:87], v[24:27], v[64:67], v[72:87]
  ds_read_b128 v[24:27], v1 offset:14336
  v_exp_f32 v96, v44
  v_cvt_pk_bf16_f32 v68, v40, v41
  v_exp_f32 v97, v45
  v_cvt_pk_bf16_f32 v69, v42, v43
  v_exp_f32 v98, v46
  v_exp_f32 v99, v47
  s_waitcnt lgkmcnt(2)
  v_mfma_f32_32x32x16_bf16 v[32:47], v[16:19], v[8:11], 0
  ds_read_b128 v[16:19], v2 offset:4096
  v_exp_f32 v48, v48
  v_cvt_pk_bf16_f32 v70, v96, v97
  v_exp_f32 v49, v49
  v_cvt_pk_bf16_f32 v71, v98, v99
  v_exp_f32 v50, v50
  v_exp_f32 v51, v51
  v_mfma_f32_32x32x16_bf16 v[32:47], v[20:23], v[12:15], v[32:47]
  ds_read_b128 v[20:23], v2 offset:5120
  v_exp_f32 v52, v52
  v_cvt_pk_bf16_f32 v64, v48, v49
  v_exp_f32 v53, v53
  v_cvt_pk_bf16_f32 v65, v50, v51
  v_exp_f32 v54, v54
  v_exp_f32 v55, v55
  s_waitcnt lgkmcnt(2)
  v_mfma_f32_32x32x16_bf16 v[72:87], v[28:31], v[68:71], v[72:87]
  ds_read_b128 v[28:31], v1 offset:15360
  v_exp_f32 v56, v56
  v_cvt_pk_bf16_f32 v66, v52, v53
  v_exp_f32 v57, v57
  v_cvt_pk_bf16_f32 v67, v54, v55
  v_exp_f32 v58, v58
  v_exp_f32 v59, v59
  v_mfma_f32_32x32x16_bf16 v[72:87], v[24:27], v[64:67], v[72:87]
  ds_read_b128 v[24:27], v2 offset:2048
  v_exp_f32 v96, v60
  v_cvt_pk_bf16_f32 v68, v56, v57
  v_exp_f32 v97, v61
  v_cvt_pk_bf16_f32 v69, v58, v59
  v_mov_b32 v1, v2
  v_add_u32 v2, s47, v0
  v_add_u32 v6, 8, v6
  v_xor_b32 v4, 128, v6
  s_add_u32 s47, s47, 32768
  s_cmp_ge_u32 s47, 98304
  s_cselect_b32 s3, 98304, 0
  s_sub_u32 s47, s47, s3
  s_mov_b64 exec, 1
  v_mov_b32 v92, 113764
  s_waitcnt vmcnt(4)
  ds_add_rtn_u32 v90, v92, v88
  s_waitcnt lgkmcnt(0)
  v_cmp_eq_u32 vcc, 7, v90
  s_nop 0
  s_and_b64 exec, exec, vcc
  s_cbranch_execz L_nhfa
  buffer_store_dwordx2 v[100:101], off, s[40:43], s73 sc1
L_nhfa:
  s_mov_b64 exec, -1
  v_mov_b32 v89, 1
  v_exp_f32 v98, v62
  v_exp_f32 v99, v63
  s_branch L_aloop
L_btype:
  ds_read_b64_tr_b16 v[148:149], v1 offset:0
  ds_read_b64_tr_b16 v[150:151], v1 offset:256
  ds_read_b64_tr_b16 v[152:153], v1 offset:8192
  ds_read_b64_tr_b16 v[154:155], v1 offset:8448
  ds_read_b64_tr_b16 v[156:157], v1 offset:2048
  ds_read_b64_tr_b16 v[158:159], v1 offset:2304
  s_waitcnt lgkmcnt(4)
  v_mfma_f32_32x32x16_bf16 v[116:131], v[148:151], v[4:7], 0
  ds_read_b64_tr_b16 v[148:149], v1 offset:10240
  ds_read_b64_tr_b16 v[150:151], v1 offset:10496
  v_lshlrev_b32 v160, 16, v40
  v_and_b32 v161, s66, v40
  v_lshlrev_b32 v162, 16, v41
  v_and_b32 v163, s66, v41
  v_fma_f32 v160, v160, v164, v165
  v_fma_f32 v161, v161, v164, v165
  v_lshlrev_b32 v166, 16, v42
  s_waitcnt lgkmcnt(4)
  v_mfma_f32_32x32x16_bf16 v[132:147], v[152:155], v[4:7], 0
  ds_read_b64_tr_b16 v[152:153], v1 offset:4096
  ds_read_b64_tr_b16 v[154:155], v1 offset:4352
  v_and_b32 v167, s66, v42
  v_fma_f32 v162, v162, v164, v165
  v_fma_f32 v163, v163, v164, v165
  v_cvt_pk_bf16_f32 v40, v160, v161
  v_lshlrev_b32 v160, 16, v43
  v_and_b32 v161, s66, v43
  v_fma_f32 v166, v166, v164, v165
  v_fma_f32 v167, v167, v164, v165
  s_waitcnt lgkmcnt(4)
  v_mfma_f32_32x32x16_bf16 v[116:131], v[156:159], v[8:11], v[116:131]
  ds_read_b64_tr_b16 v[156:157], v1 offset:12288
  ds_read_b64_tr_b16 v[158:159], v1 offset:12544
  v_cvt_pk_bf16_f32 v41, v162, v163
  v_lshlrev_b32 v162, 16, v44
  v_and_b32 v163, s66, v44
  v_fma_f32 v160, v160, v164, v165
  v_fma_f32 v161, v161, v164, v165
  v_cvt_pk_bf16_f32 v42, v166, v167
  v_lshlrev_b32 v166, 16, v45
  s_waitcnt lgkmcnt(4)
  v_mfma_f32_32x32x16_bf16 v[132:147], v[148:151], v[8:11], v[132:147]
  ds_read_b64_tr_b16 v[148:149], v1 offset:6144
  ds_read_b64_tr_b16 v[150:151], v1 offset:6400
  v_and_b32 v167, s66, v45
  v_fma_f32 v162, v162, v164, v165
  v_fma_f32 v163, v163, v164, v165
  v_cvt_pk_bf16_f32 v43, v160, v161
  v_lshlrev_b32 v160, 16, v46
  v_and_b32 v161, s66, v46
  v_fma_f32 v166, v166, v164, v165
  s_waitcnt lgkmcnt(4)
  v_mfma_f32_32x32x16_bf16 v[116:131], v[152:155], v[12:15], v[116:131]
  ds_read_b64_tr_b16 v[152:153], v1 offset:14336
  ds_read_b64_tr_b16 v[154:155], v1 offset:14592
  v_add_u32 v1, 147456, v3
  v_fma_f32 v167, v167, v164, v165
  v_cvt_pk_bf16_f32 v44, v162, v163
  v_lshlrev_b32 v162, 16, v47
  v_and_b32 v163, s66, v47
  v_fma_f32 v160, v160, v164, v165
  v_fma_f32 v161, v161, v164, v165
  v_cvt_pk_bf16_f32 v45, v166, v167
  v_lshlrev_b32 v166, 16, v48
  s_waitcnt lgkmcnt(4)
  v_mfma_f32_32x32x16_bf16 v[132:147], v[156:159], v[12:15], v[132:147]
  ds_read_b64_tr_b16 v[156:157], v2 offset:0
  ds_read_b64_tr_b16 v[158:159], v2 offset:256
  v_and_b32 v167, s66, v48
  v_fma_f32 v162, v162, v164, v165
  v_fma_f32 v163, v163, v164, v165
  v_cvt_pk_bf16_f32 v46, v160, v161
  v_lshlrev_b32 v160, 16, v49
  v_and_b32 v161, s66, v49
  v_fma_f32 v166, v166, v164, v165
  s_waitcnt lgkmcnt(4)
  v_mfma_f32_32x32x16_bf16 v[116:131], v[148:151], v[16:19], v[116:131]
  ds_read_b64_tr_b16 v[148:149], v2 offset:8192
  ds_read_b64_tr_b16 v[150:151], v2 offset:8448
  v_fma_f32 v167, v167, v164, v165
  v_cvt_pk_bf16_f32 v47, v162, v163
  v_lshlrev_b32 v162, 16, v50
  v_and_b32 v163, s66, v50
  v_fma_f32 v160, v160, v164, v165
  v_fma_f32 v161, v161, v164, v165
  v_cvt_pk_bf16_f32 v48, v166, v167
  s_waitcnt lgkmcnt(4)
  v_mfma_f32_32x32x16_bf16 v[132:147], v[152:155], v[16:19], v[132:147]
  s_barrier
  ds_read_b64_tr_b16 v[152:153], v2 offset:2048
  ds_read_b64_tr_b16 v[154:155], v2 offset:2304
  v_lshlrev_b32 v166, 16, v51
  v_and_b32 v167, s66, v51
  v_fma_f32 v162, v162, v164, v165
  v_fma_f32 v163, v163, v164, v165
  v_cvt_pk_bf16_f32 v49, v160, v161
  v_lshlrev_b32 v160, 16, v52
  v_and_b32 v161, s66, v52
  s_waitcnt lgkmcnt(4)
  v_mfma_f32_32x32x16_bf16 v[116:131], v[156:159], v[20:23], v[116:131]
  ds_read_b64_tr_b16 v[156:157], v2 offset:10240
  ds_read_b64_tr_b16 v[158:159], v2 offset:10496
  v_fma_f32 v166, v166, v164, v165
  v_fma_f32 v167, v167, v164, v165
  v_cvt_pk_bf16_f32 v50, v162, v163
  v_lshlrev_b32 v162, 16, v53
  v_and_b32 v163, s66, v53
  v_fma_f32 v160, v160, v164, v165
  v_fma_f32 v161, v161, v164, v165
  v_cvt_pk_bf16_f32 v51, v166, v167
  s_waitcnt lgkmcnt(4)
  v_mfma_f32_32x32x16_bf16 v[132:147], v[148:151], v[20:23], v[132:147]
  ds_read_b64_tr_b16 v[148:149], v2 offset:4096
  ds_read_b64_tr_b16 v[150:151], v2 offset:4352
  v_lshlrev_b32 v166, 16, v54
  v_and_b32 v167, s66, v54
  v_fma_f32 v162, v162, v164, v165
  v_fma_f32 v163, v163, v164, v165
  v_cvt_pk_bf16_f32 v52, v160, v161
  v_lshlrev_b32 v160, 16, v55
  v_and_b32 v161, s66, v55
  s_waitcnt lgkmcnt(4)
  v_mfma_f32_32x32x16_bf16 v[116:131], v[152:155], v[24:27], v[116:131]
  ds_read_b64_tr_b16 v[152:153], v2 offset:12288
  ds_read_b64_tr_b16 v[154:155], v2 offset:12544
  v_fma_f32 v166, v166, v164, v165
  v_fma_f32 v167, v167, v164, v165
  v_cvt_pk_bf16_f32 v53, v162, v163
  v_lshlrev_b32 v162, 16, v56
  v_and_b32 v163, s66, v56
  v_fma_f32 v160, v160, v164, v165
  v_fma_f32 v161, v161, v164, v165
  s_waitcnt lgkmcnt(4)
  v_mfma_f32_32x32x16_bf16 v[132:147], v[156:159], v[24:27], v[132:147]
  ds_read_b64_tr_b16 v[156:157], v2 offset:6144
  ds_read_b64_tr_b16 v[158:159], v2 offset:6400
  v_cvt_pk_bf16_f32 v54, v166, v167
  v_lshlrev_b32 v166, 16, v57
  v_and_b32 v167, s66, v57
  v_fma_f32 v162, v162, v164, v165
  v_fma_f32 v163, v163, v164, v165
  v_cvt_pk_bf16_f32 v55, v160, v161
  v_lshlrev_b32 v160, 16, v58
  v_and_b32 v161, s66, v58
  s_waitcnt lgkmcnt(4)
  v_mfma_f32_32x32x16_bf16 v[116:131], v[148:151], v[28:31], v[116:131]
  ds_read_b64_tr_b16 v[148:149], v2 offset:14336
  ds_read_b64_tr_b16 v[150:151], v2 offset:14592
  v_add_u32 v2, 0, v3
  v_fma_f32 v166, v166, v164, v165
  v_fma_f32 v167, v167, v164, v165
  v_cvt_pk_bf16_f32 v56, v162, v163
  v_lshlrev_b32 v162, 16, v59
  v_and_b32 v163, s66, v59
  v_fma_f32 v160, v160, v164, v165
  v_fma_f32 v161, v161, v164, v165
  s_waitcnt lgkmcnt(4)
  v_mfma_f32_32x32x16_bf16 v[132:147], v[152:155], v[28:31], v[132:147]
  ds_read_b64_tr_b16 v[152:153], v1 offset:0
  ds_read_b64_tr_b16 v[154:155], v1 offset:256
  v_cvt_pk_bf16_f32 v57, v166, v167
  v_lshlrev_b32 v166, 16, v60
  v_and_b32 v167, s66, v60
  v_fma_f32 v162, v162, v164, v165
  v_fma_f32 v163, v163, v164, v165
  v_cvt_pk_bf16_f32 v58, v160, v161
  v_lshlrev_b32 v160, 16, v61
  s_waitcnt lgkmcnt(4)
  v_mfma_f32_32x32x16_bf16 v[116:131], v[156:159], v[32:35], v[116:131]
  ds_read_b64_tr_b16 v[156:157], v1 offset:8192
  ds_read_b64_tr_b16 v[158:159], v1 offset:8448
  v_and_b32 v161, s66, v61
  v_fma_f32 v166, v166, v164, v165
  v_fma_f32 v167, v167, v164, v165
  v_cvt_pk_bf16_f32 v59, v162, v163
  v_lshlrev_b32 v162, 16, v62
  v_and_b32 v163, s66, v62
  v_fma_f32 v160, v160, v164, v165
  v_fma_f32 v161, v161, v164, v165
  s_waitcnt lgkmcnt(4)
  v_mfma_f32_32x32x16_bf16 v[132:147], v[148:151], v[32:35], v[132:147]
  s_barrier
  ds_read_b64_tr_b16 v[148:149], v1 offset:2048
  ds_read_b64_tr_b16 v[150:151], v1 offset:2304
  v_cvt_pk_bf16_f32 v60, v166, v167
  v_lshlrev_b32 v166, 16, v63
  v_and_b32 v167, s66, v63
  v_fma_f32 v162, v162, v164, v165
  v_fma_f32 v163, v163, v164, v165
  v_cvt_pk_bf16_f32 v61, v160, v161
  v_lshlrev_b32 v160, 16, v64
  s_waitcnt lgkmcnt(4)
  v_mfma_f32_32x32x16_bf16 v[116:131], v[152:155], v[36:39], v[116:131]
  ds_read_b64_tr_b16 v[152:153], v1 offset:10240
  ds_read_b64_tr_b16 v[154:155], v1 offset:10496
  v_and_b32 v161, s66, v64
  v_fma_f32 v166, v166, v164, v165
  v_fma_f32 v167, v167, v164, v165
  v_cvt_pk_bf16_f32 v62, v162, v163
  v_lshlrev_b32 v162, 16, v65
  v_and_b32 v163, s66, v65
  v_fma_f32 v160, v160, v164, v165
  s_waitcnt lgkmcnt(4)
  v_mfma_f32_32x32x16_bf16 v[132:147], v[156:159], v[36:39], v[132:147]
  ds_read_b64_tr_b16 v[156:157], v1 offset:4096
  ds_read_b64_tr_b16 v[158:159], v1 offset:4352
  v_fma_f32 v161, v161, v164, v165
  v_cvt_pk_bf16_f32 v63, v166, v167
  v_lshlrev_b32 v166, 16, v66
  v_and_b32 v167, s66, v66
  v_fma_f32 v162, v162, v164, v165
  v_fma_f32 v163, v163, v164, v165
  v_cvt_pk_bf16_f32 v64, v160, v161
  v_lshlrev_b32 v160, 16, v67
  s_waitcnt lgkmcnt(4)
  v_mfma_f32_32x32x16_bf16 v[116:131], v[148:151], v[40:43], v[116:131]
  ds_read_b64_tr_b16 v[148:149], v1 offset:12288
  ds_read_b64_tr_b16 v[150:151], v1 offset:12544
  v_and_b32 v161, s66, v67
  v_fma_f32 v166, v166, v164, v165
  v_fma_f32 v167, v167, v164, v165
  v_cvt_pk_bf16_f32 v65, v162, v163
  v_lshlrev_b32 v162, 16, v68
  v_and_b32 v163, s66, v68
  v_fma_f32 v160, v160, v164, v165
  s_waitcnt lgkmcnt(4)
  v_mfma_f32_32x32x16_bf16 v[132:147], v[152:155], v[40:43], v[132:147]
  ds_read_b64_tr_b16 v[152:153], v1 offset:6144
  ds_read_b64_tr_b16 v[154:155], v1 offset:6400
  v_fma_f32 v161, v161, v164, v165
  v_cvt_pk_bf16_f32 v66, v166, v167
  v_lshlrev_b32 v166, 16, v69
  v_and_b32 v167, s66, v69
  v_fma_f32 v162, v162, v164, v165
  v_fma_f32 v163, v163, v164, v165
  v_cvt_pk_bf16_f32 v67, v160, v161
  s_waitcnt lgkmcnt(4)
  v_mfma_f32_32x32x16_bf16 v[116:131], v[156:159], v[44:47], v[116:131]
  ds_read_b64_tr_b16 v[156:157], v1 offset:14336
  ds_read_b64_tr_b16 v[158:159], v1 offset:14592
  v_add_u32 v1, 16384, v3
  v_lshlrev_b32 v160, 16, v70
  v_and_b32 v161, s66, v70
  v_fma_f32 v166, v166, v164, v165
  v_fma_f32 v167, v167, v164, v165
  v_cvt_pk_bf16_f32 v68, v162, v163
  v_lshlrev_b32 v162, 16, v71
  v_and_b32 v163, s66, v71
  s_waitcnt lgkmcnt(4)
  v_mfma_f32_32x32x16_bf16 v[132:147], v[148:151], v[44:47], v[132:147]
  ds_read_b64_tr_b16 v[148:149], v2 offset:0
  ds_read_b64_tr_b16 v[150:151], v2 offset:256
  v_fma_f32 v160, v160, v164, v165
  v_fma_f32 v161, v161, v164, v165
  v_cvt_pk_bf16_f32 v69, v166, v167
  v_lshlrev_b32 v166, 16, v72
  v_and_b32 v167, s66, v72
  v_fma_f32 v162, v162, v164, v165
  v_fma_f32 v163, v163, v164, v165
  v_cvt_pk_bf16_f32 v70, v160, v161
  s_waitcnt lgkmcnt(4)
  v_mfma_f32_32x32x16_bf16 v[116:131], v[152:155], v[48:51], v[116:131]
  ds_read_b64_tr_b16 v[152:153], v2 offset:8192
  ds_read_b64_tr_b16 v[154:155], v2 offset:8448
  v_lshlrev_b32 v160, 16, v73
  v_and_b32 v161, s66, v73
  v_fma_f32 v166, v166, v164, v165
  v_fma_f32 v167, v167, v164, v165
  v_cvt_pk_bf16_f32 v71, v162, v163
  v_lshlrev_b32 v162, 16, v74
  v_and_b32 v163, s66, v74
  s_waitcnt lgkmcnt(4)
  v_mfma_f32_32x32x16_bf16 v[132:147], v[156:159], v[48:51], v[132:147]
  s_barrier
  ds_read_b64_tr_b16 v[156:157], v2 offset:2048
  ds_read_b64_tr_b16 v[158:159], v2 offset:2304
  v_fma_f32 v160, v160, v164, v165
  v_fma_f32 v161, v161, v164, v165
  v_cvt_pk_bf16_f32 v72, v166, v167
  v_lshlrev_b32 v166, 16, v75
  v_and_b32 v167, s66, v75
  v_fma_f32 v162, v162, v164, v165
  v_fma_f32 v163, v163, v164, v165
  s_waitcnt lgkmcnt(4)
  v_mfma_f32_32x32x16_bf16 v[116:131], v[148:151], v[52:55], v[116:131]
  ds_read_b64_tr_b16 v[148:149], v2 offset:10240
  ds_read_b64_tr_b16 v[150:151], v2 offset:10496
  v_cvt_pk_bf16_f32 v73, v160, v161
  v_lshlrev_b32 v160, 16, v76
  v_and_b32 v161, s66, v76
  v_fma_f32 v166, v166, v164, v165
  v_fma_f32 v167, v167, v164, v165
  v_cvt_pk_bf16_f32 v74, v162, v163
  v_lshlrev_b32 v162, 16, v77
  v_and_b32 v163, s66, v77
  s_waitcnt lgkmcnt(4)
  v_mfma_f32_32x32x16_bf16 v[132:147], v[152:155], v[52:55], v[132:147]
  ds_read_b64_tr_b16 v[152:153], v2 offset:4096
  ds_read_b64_tr_b16 v[154:155], v2 offset:4352
  v_fma_f32 v160, v160, v164, v165
  v_fma_f32 v161, v161, v164, v165
  v_cvt_pk_bf16_f32 v75, v166, v167
  v_lshlrev_b32 v166, 16, v78
  v_and_b32 v167, s66, v78
  v_fma_f32 v162, v162, v164, v165
  v_fma_f32 v163, v163, v164, v165
  s_waitcnt lgkmcnt(4)
  v_mfma_f32_32x32x16_bf16 v[116:131], v[156:159], v[56:59], v[116:131]
  ds_read_b64_tr_b16 v[156:157], v2 offset:12288
  ds_read_b64_tr_b16 v[158:159], v2 offset:12544
  v_cvt_pk_bf16_f32 v76, v160, v161
  v_lshlrev_b32 v160, 16, v79
  v_and_b32 v161, s66, v79
  v_fma_f32 v166, v166, v164, v165
  v_fma_f32 v167, v167, v164, v165
  v_cvt_pk_bf16_f32 v77, v162, v163
  v_lshlrev_b32 v162, 16, v80
  s_waitcnt lgkmcnt(4)
  v_mfma_f32_32x32x16_bf16 v[132:147], v[148:151], v[56:59], v[132:147]
  ds_read_b64_tr_b16 v[148:149], v2 offset:6144
  ds_read_b64_tr_b16 v[150:151], v2 offset:6400
  v_and_b32 v163, s66, v80
  v_fma_f32 v160, v160, v164, v165
  v_fma_f32 v161, v161, v164, v165
  v_cvt_pk_bf16_f32 v78, v166, v167
  v_lshlrev_b32 v166, 16, v81
  v_and_b32 v167, s66, v81
  v_fma_f32 v162, v162, v164, v165
  v_fma_f32 v163, v163, v164, v165
  s_waitcnt lgkmcnt(4)
  v_mfma_f32_32x32x16_bf16 v[116:131], v[152:155], v[60:63], v[116:131]
  ds_read_b64_tr_b16 v[152:153], v2 offset:14336
  ds_read_b64_tr_b16 v[154:155], v2 offset:14592
  v_add_u32 v2, 32768, v3
  v_cvt_pk_bf16_f32 v79, v160, v161
  v_lshlrev_b32 v160, 16, v82
  v_and_b32 v161, s66, v82
  v_fma_f32 v166, v166, v164, v165
  v_fma_f32 v167, v167, v164, v165
  v_cvt_pk_bf16_f32 v80, v162, v163
  v_lshlrev_b32 v162, 16, v83
  s_waitcnt lgkmcnt(4)
  v_mfma_f32_32x32x16_bf16 v[132:147], v[156:159], v[60:63], v[132:147]
  ds_read_b64_tr_b16 v[156:157], v1 offset:0
  ds_read_b64_tr_b16 v[158:159], v1 offset:256
  v_and_b32 v163, s66, v83
  v_fma_f32 v160, v160, v164, v165
  v_fma_f32 v161, v161, v164, v165
  v_cvt_pk_bf16_f32 v81, v166, v167
  v_lshlrev_b32 v166, 16, v84
  v_and_b32 v167, s66, v84
  v_fma_f32 v162, v162, v164, v165
  s_waitcnt lgkmcnt(4)
  v_mfma_f32_32x32x16_bf16 v[116:131], v[148:151], v[64:67], v[116:131]
  ds_read_b64_tr_b16 v[148:149], v1 offset:8192
  ds_read_b64_tr_b16 v[150:151], v1 offset:8448
  v_fma_f32 v163, v163, v164, v165
  v_cvt_pk_bf16_f32 v82, v160, v161
  v_lshlrev_b32 v160, 16, v85
  v_and_b32 v161, s66, v85
  v_fma_f32 v166, v166, v164, v165
  v_fma_f32 v167, v167, v164, v165
  v_cvt_pk_bf16_f32 v83, v162, v163
  v_lshlrev_b32 v162, 16, v86
  s_waitcnt lgkmcnt(4)
  v_mfma_f32_32x32x16_bf16 v[132:147], v[152:155], v[64:67], v[132:147]
  s_barrier
  ds_read_b64_tr_b16 v[152:153], v1 offset:2048
  ds_read_b64_tr_b16 v[154:155], v1 offset:2304
  v_and_b32 v163, s66, v86
  v_fma_f32 v160, v160, v164, v165
  v_fma_f32 v161, v161, v164, v165
  v_cvt_pk_bf16_f32 v84, v166, v167
  v_lshlrev_b32 v166, 16, v87
  v_and_b32 v167, s66, v87
  v_fma_f32 v162, v162, v164, v165
  s_waitcnt lgkmcnt(4)
  v_mfma_f32_32x32x16_bf16 v[116:131], v[156:159], v[68:71], v[116:131]
  ds_read_b64_tr_b16 v[156:157], v1 offset:10240
  ds_read_b64_tr_b16 v[158:159], v1 offset:10496
  v_fma_f32 v163, v163, v164, v165
  v_cvt_pk_bf16_f32 v85, v160, v161
  v_lshlrev_b32 v160, 16, v88
  v_and_b32 v161, s66, v88
  v_fma_f32 v166, v166, v164, v165
  v_fma_f32 v167, v167, v164, v165
  v_cvt_pk_bf16_f32 v86, v162, v163
  s_waitcnt lgkmcnt(4)
  v_mfma_f32_32x32x16_bf16 v[132:147], v[148:151], v[68:71], v[132:147]
  ds_read_b64_tr_b16 v[148:149], v1 offset:4096
  ds_read_b64_tr_b16 v[150:151], v1 offset:4352
  v_lshlrev_b32 v162, 16, v89
  v_and_b32 v163, s66, v89
  v_fma_f32 v160, v160, v164, v165
  v_fma_f32 v161, v161, v164, v165
  v_cvt_pk_bf16_f32 v87, v166, v167
  v_lshlrev_b32 v166, 16, v90
  v_and_b32 v167, s66, v90
  s_waitcnt lgkmcnt(4)
  v_mfma_f32_32x32x16_bf16 v[116:131], v[152:155], v[72:75], v[116:131]
  ds_read_b64_tr_b16 v[152:153], v1 offset:12288
  ds_read_b64_tr_b16 v[154:155], v1 offset:12544
  v_fma_f32 v162, v162, v164, v165
  v_fma_f32 v163, v163, v164, v165
  v_cvt_pk_bf16_f32 v88, v160, v161
  v_lshlrev_b32 v160, 16, v91
  v_and_b32 v161, s66, v91
  v_fma_f32 v166, v166, v164, v165
  v_fma_f32 v167, v167, v164, v165
  v_cvt_pk_bf16_f32 v89, v162, v163
  s_waitcnt lgkmcnt(4)
  v_mfma_f32_32x32x16_bf16 v[132:147], v[156:159], v[72:75], v[132:147]
  ds_read_b64_tr_b16 v[156:157], v1 offset:6144
  ds_read_b64_tr_b16 v[158:159], v1 offset:6400
  v_lshlrev_b32 v162, 16, v92
  v_and_b32 v163, s66, v92
  v_fma_f32 v160, v160, v164, v165
  v_fma_f32 v161, v161, v164, v165
  v_cvt_pk_bf16_f32 v90, v166, v167
  v_lshlrev_b32 v166, 16, v93
  v_and_b32 v167, s66, v93
  s_waitcnt lgkmcnt(4)
  v_mfma_f32_32x32x16_bf16 v[116:131], v[148:151], v[76:79], v[116:131]
  ds_read_b64_tr_b16 v[148:149], v1 offset:14336
  ds_read_b64_tr_b16 v[150:151], v1 offset:14592
  v_add_u32 v1, 49152, v3
  v_fma_f32 v162, v162, v164, v165
  v_fma_f32 v163, v163, v164, v165
  v_cvt_pk_bf16_f32 v91, v160, v161
  v_lshlrev_b32 v160, 16, v94
  v_and_b32 v161, s66, v94
  v_fma_f32 v166, v166, v164, v165
  v_fma_f32 v167, v167, v164, v165
  s_waitcnt lgkmcnt(4)
  v_mfma_f32_32x32x16_bf16 v[132:147], v[152:155], v[76:79], v[132:147]
  ds_read_b64_tr_b16 v[152:153], v2 offset:0
  ds_read_b64_tr_b16 v[154:155], v2 offset:256
  v_cvt_pk_bf16_f32 v92, v162, v163
  v_lshlrev_b32 v162, 16, v95
  v_and_b32 v163, s66, v95
  v_fma_f32 v160, v160, v164, v165
  v_fma_f32 v161, v161, v164, v165
  v_cvt_pk_bf16_f32 v93, v166, v167
  v_lshlrev_b32 v166, 16, v96
  v_and_b32 v167, s66, v96
  s_waitcnt lgkmcnt(4)
  v_mfma_f32_32x32x16_bf16 v[116:131], v[156:159], v[80:83], v[116:131]
  ds_read_b64_tr_b16 v[156:157], v2 offset:8192
  ds_read_b64_tr_b16 v[158:159], v2 offset:8448
  v_fma_f32 v162, v162, v164, v165
  v_fma_f32 v163, v163, v164, v165
  v_cvt_pk_bf16_f32 v94, v160, v161
  v_lshlrev_b32 v160, 16, v97
  v_and_b32 v161, s66, v97
  v_fma_f32 v166, v166, v164, v165
  v_fma_f32 v167, v167, v164, v165
  s_waitcnt lgkmcnt(4)
  v_mfma_f32_32x32x16_bf16 v[132:147], v[148:151], v[80:83], v[132:147]
  s_barrier
  ds_read_b64_tr_b16 v[148:149], v2 offset:2048
  ds_read_b64_tr_b16 v[150:151], v2 offset:2304
  v_cvt_pk_bf16_f32 v95, v162, v163
  v_lshlrev_b32 v162, 16, v98
  v_and_b32 v163, s66, v98
  v_fma_f32 v160, v160, v164, v165
  v_fma_f32 v161, v161, v164, v165
  v_cvt_pk_bf16_f32 v96, v166, v167
  v_lshlrev_b32 v166, 16, v99
  s_waitcnt lgkmcnt(4)
  v_mfma_f32_32x32x16_bf16 v[116:131], v[152:155], v[84:87], v[116:131]
  ds_read_b64_tr_b16 v[152:153], v2 offset:10240
  ds_read_b64_tr_b16 v[154:155], v2 offset:10496
  v_and_b32 v167, s66, v99
  v_fma_f32 v162, v162, v164, v165
  v_fma_f32 v163, v163, v164, v165
  v_cvt_pk_bf16_f32 v97, v160, v161
  v_lshlrev_b32 v160, 16, v100
  v_and_b32 v161, s66, v100
  v_fma_f32 v166, v166, v164, v165
  v_fma_f32 v167, v167, v164, v165
  s_waitcnt lgkmcnt(4)
  v_mfma_f32_32x32x16_bf16 v[132:147], v[156:159], v[84:87], v[132:147]
  ds_read_b64_tr_b16 v[156:157], v2 offset:4096
  ds_read_b64_tr_b16 v[158:159], v2 offset:4352
  v_cvt_pk_bf16_f32 v98, v162, v163
  v_lshlrev_b32 v162, 16, v101
  v_and_b32 v163, s66, v101
  v_fma_f32 v160, v160, v164, v165
  v_fma_f32 v161, v161, v164, v165
  v_cvt_pk_bf16_f32 v99, v166, v167
  v_lshlrev_b32 v166, 16, v102
  s_waitcnt lgkmcnt(4)
  v_mfma_f32_32x32x16_bf16 v[116:131], v[148:151], v[88:91], v[116:131]
  ds_read_b64_tr_b16 v[148:149], v2 offset:12288
  ds_read_b64_tr_b16 v[150:151], v2 offset:12544
  v_and_b32 v167, s66, v102
  v_fma_f32 v162, v162, v164, v165
  v_fma_f32 v163, v163, v164, v165
  v_cvt_pk_bf16_f32 v100, v160, v161
  v_lshlrev_b32 v160, 16, v103
  v_and_b32 v161, s66, v103
  v_fma_f32 v166, v166, v164, v165
  s_waitcnt lgkmcnt(4)
  v_mfma_f32_32x32x16_bf16 v[132:147], v[152:155], v[88:91], v[132:147]
  ds_read_b64_tr_b16 v[152:153], v2 offset:6144
  ds_read_b64_tr_b16 v[154:155], v2 offset:6400
  v_fma_f32 v167, v167, v164, v165
  v_cvt_pk_bf16_f32 v101, v162, v163
  v_lshlrev_b32 v162, 16, v104
  v_and_b32 v163, s66, v104
  v_fma_f32 v160, v160, v164, v165
  v_fma_f32 v161, v161, v164, v165
  v_cvt_pk_bf16_f32 v102, v166, v167
  v_lshlrev_b32 v166, 16, v105
  s_waitcnt lgkmcnt(4)
  v_mfma_f32_32x32x16_bf16 v[116:131], v[156:159], v[92:95], v[116:131]
  ds_read_b64_tr_b16 v[156:157], v2 offset:14336
  ds_read_b64_tr_b16 v[158:159], v2 offset:14592
  v_add_u32 v2, 65536, v3
  v_and_b32 v167, s66, v105
  v_fma_f32 v162, v162, v164, v165
  v_fma_f32 v163, v163, v164, v165
  v_cvt_pk_bf16_f32 v103, v160, v161
  v_lshlrev_b32 v160, 16, v106
  v_and_b32 v161, s66, v106
  v_fma_f32 v166, v166, v164, v165
  s_waitcnt lgkmcnt(4)
  v_mfma_f32_32x32x16_bf16 v[132:147], v[148:151], v[92:95], v[132:147]
  ds_read_b64_tr_b16 v[148:149], v1 offset:0
  ds_read_b64_tr_b16 v[150:151], v1 offset:256
  v_fma_f32 v167, v167, v164, v165
  v_cvt_pk_bf16_f32 v104, v162, v163
  v_lshlrev_b32 v162, 16, v107
  v_and_b32 v163, s66, v107
  v_fma_f32 v160, v160, v164, v165
  v_fma_f32 v161, v161, v164, v165
  v_cvt_pk_bf16_f32 v105, v166, v167
  s_waitcnt lgkmcnt(4)
  v_mfma_f32_32x32x16_bf16 v[116:131], v[152:155], v[96:99], v[116:131]
  ds_read_b64_tr_b16 v[152:153], v1 offset:8192
  ds_read_b64_tr_b16 v[154:155], v1 offset:8448
  v_lshlrev_b32 v166, 16, v108
  v_and_b32 v167, s66, v108
  v_fma_f32 v162, v162, v164, v165
  v_fma_f32 v163, v163, v164, v165
  v_cvt_pk_bf16_f32 v106, v160, v161
  v_lshlrev_b32 v160, 16, v109
  v_and_b32 v161, s66, v109
  s_waitcnt lgkmcnt(4)
  v_mfma_f32_32x32x16_bf16 v[132:147], v[156:159], v[96:99], v[132:147]
  s_barrier
  ds_read_b64_tr_b16 v[156:157], v1 offset:2048
  ds_read_b64_tr_b16 v[158:159], v1 offset:2304
  v_fma_f32 v166, v166, v164, v165
  v_fma_f32 v167, v167, v164, v165
  v_cvt_pk_bf16_f32 v107, v162, v163
  v_lshlrev_b32 v162, 16, v110
  v_and_b32 v163, s66, v110
  v_fma_f32 v160, v160, v164, v165
  v_fma_f32 v161, v161, v164, v165
  v_cvt_pk_bf16_f32 v108, v166, v167
  s_waitcnt lgkmcnt(4)
  v_mfma_f32_32x32x16_bf16 v[116:131], v[148:151], v[100:103], v[116:131]
  ds_read_b64_tr_b16 v[148:149], v1 offset:10240
  ds_read_b64_tr_b16 v[150:151], v1 offset:10496
  v_lshlrev_b32 v166, 16, v111
  v_and_b32 v167, s66, v111
  v_fma_f32 v162, v162, v164, v165
  v_fma_f32 v163, v163, v164, v165
  v_cvt_pk_bf16_f32 v109, v160, v161
  v_lshlrev_b32 v160, 16, v112
  v_and_b32 v161, s66, v112
  s_waitcnt lgkmcnt(4)
  v_mfma_f32_32x32x16_bf16 v[132:147], v[152:155], v[100:103], v[132:147]
  ds_read_b64_tr_b16 v[152:153], v1 offset:4096
  ds_read_b64_tr_b16 v[154:155], v1 offset:4352
  v_fma_f32 v166, v166, v164, v165
  v_fma_f32 v167, v167, v164, v165
  v_cvt_pk_bf16_f32 v110, v162, v163
  v_lshlrev_b32 v162, 16, v113
  v_and_b32 v163, s66, v113
  v_fma_f32 v160, v160, v164, v165
  v_fma_f32 v161, v161, v164, v165
  s_waitcnt lgkmcnt(4)
  v_mfma_f32_32x32x16_bf16 v[116:131], v[156:159], v[104:107], v[116:131]
  ds_read_b64_tr_b16 v[156:157], v1 offset:12288
  ds_read_b64_tr_b16 v[158:159], v1 offset:12544
  v_cvt_pk_bf16_f32 v111, v166, v167
  v_lshlrev_b32 v166, 16, v114
  v_and_b32 v167, s66, v114
  v_fma_f32 v162, v162, v164, v165
  v_fma_f32 v163, v163, v164, v165
  v_cvt_pk_bf16_f32 v112, v160, v161
  v_lshlrev_b32 v160, 16, v115
  v_and_b32 v161, s66, v115
  s_waitcnt lgkmcnt(4)
  v_mfma_f32_32x32x16_bf16 v[132:147], v[148:151], v[104:107], v[132:147]
  ds_read_b64_tr_b16 v[148:149], v1 offset:6144
  ds_read_b64_tr_b16 v[150:151], v1 offset:6400
  v_fma_f32 v166, v166, v164, v165
  v_fma_f32 v167, v167, v164, v165
  v_cvt_pk_bf16_f32 v113, v162, v163
  v_fma_f32 v160, v160, v164, v165
  v_fma_f32 v161, v161, v164, v165
  v_cvt_pk_bf16_f32 v114, v166, v167
  v_cvt_pk_bf16_f32 v115, v160, v161
  s_waitcnt lgkmcnt(4)
  v_mfma_f32_32x32x16_bf16 v[116:131], v[152:155], v[108:111], v[116:131]
  ds_read_b64_tr_b16 v[152:153], v1 offset:14336
  ds_read_b64_tr_b16 v[154:155], v1 offset:14592
  v_add_u32 v1, 81920, v3
  s_waitcnt lgkmcnt(4)
  v_mfma_f32_32x32x16_bf16 v[132:147], v[156:159], v[108:111], v[132:147]
  ds_read_b64_tr_b16 v[156:157], v2 offset:0
  ds_read_b64_tr_b16 v[158:159], v2 offset:256
  s_waitcnt lgkmcnt(4)
  v_mfma_f32_32x32x16_bf16 v[116:131], v[148:151], v[112:115], v[116:131]
  ds_read_b64_tr_b16 v[148:149], v2 offset:2048
  ds_read_b64_tr_b16 v[150:151], v2 offset:2304
  s_waitcnt lgkmcnt(4)
  v_mfma_f32_32x32x16_bf16 v[132:147], v[152:155], v[112:115], v[132:147]
  s_barrier
  ds_read_b64_tr_b16 v[152:153], v2 offset:4096
  ds_read_b64_tr_b16 v[154:155], v2 offset:4352
  s_nop 4
  v_mul_f32 v116, s69, v116
  v_mul_f32 v117, s69, v117
  v_mul_f32 v118, s69, v118
  v_mul_f32 v119, s69, v119
  v_mul_f32 v120, s69, v120
  v_mul_f32 v121, s69, v121
  v_mul_f32 v122, s69, v122
  v_mul_f32 v123, s69, v123
  v_mul_f32 v124, s69, v124
  v_mul_f32 v125, s69, v125
  v_mul_f32 v126, s69, v126
  v_mul_f32 v127, s69, v127
  v_mul_f32 v128, s69, v128
  v_mul_f32 v129, s69, v129
  v_mul_f32 v130, s69, v130
  v_mul_f32 v131, s69, v131
  v_cvt_pk_bf16_f32 v160, v116, v117
  v_cvt_pk_bf16_f32 v161, v118, v119
  v_cvt_pk_bf16_f32 v162, v120, v121
  v_cvt_pk_bf16_f32 v163, v122, v123
  v_cvt_pk_bf16_f32 v164, v124, v125
  v_cvt_pk_bf16_f32 v165, v126, v127
  v_cvt_pk_bf16_f32 v166, v128, v129
  v_cvt_pk_bf16_f32 v167, v130, v131
  s_waitcnt lgkmcnt(4)
  v_mfma_f32_32x32x16_bf16 v[116:131], v[156:159], v[4:7], 0
  ds_read_b64_tr_b16 v[156:157], v2 offset:6144
  ds_read_b64_tr_b16 v[158:159], v2 offset:6400
  s_mov_b64 exec, s[52:53]
  v_mov_b32 v160, 0
  v_mov_b32 v161, 0
  s_mov_b64 exec, s[54:55]
  v_mov_b32 v166, 0
  v_mov_b32 v167, 0
  s_mov_b64 exec, -1
  s_waitcnt lgkmcnt(4)
  v_mfma_f32_32x32x16_bf16 v[116:131], v[148:151], v[8:11], v[116:131]
  ds_read_b64_tr_b16 v[148:149], v2 offset:8192
  ds_read_b64_tr_b16 v[150:151], v2 offset:8448
  buffer_store_dwordx4 v[160:163], v0, s[40:43], s67 offen sc1
  buffer_store_dwordx4 v[164:167], v0, s[40:43], s67 offen offset:1024 sc1
  s_waitcnt lgkmcnt(4)
  v_mfma_f32_32x32x16_bf16 v[116:131], v[152:155], v[12:15], v[116:131]
  ds_read_b64_tr_b16 v[152:153], v2 offset:10240
  ds_read_b64_tr_b16 v[154:155], v2 offset:10496
  s_waitcnt lgkmcnt(4)
  v_mfma_f32_32x32x16_bf16 v[116:131], v[156:159], v[16:19], v[116:131]
  ds_read_b64_tr_b16 v[156:157], v2 offset:12288
  ds_read_b64_tr_b16 v[158:159], v2 offset:12544
  v_mul_f32 v160, s64, v132
  v_mul_f32 v161, s64, v133
  v_mul_f32 v162, s64, v134
  v_mul_f32 v163, s64, v135
  v_fma_f32 v164, v160, v160, s65
  v_fma_f32 v165, v161, v161, s65
  s_waitcnt lgkmcnt(4)
  v_mfma_f32_32x32x16_bf16 v[116:131], v[148:151], v[20:23], v[116:131]
  ds_read_b64_tr_b16 v[148:149], v2 offset:14336
  ds_read_b64_tr_b16 v[150:151], v2 offset:14592
  v_add_u32 v2, 98304, v3
  v_fma_f32 v166, v162, v162, s65
  v_fma_f32 v167, v163, v163, s65
  v_mul_f32 v160, v160, v164
  v_mul_f32 v161, v161, v165
  v_mul_f32 v162, v162, v166
  v_mul_f32 v163, v163, v167
  s_waitcnt lgkmcnt(4)
  v_mfma_f32_32x32x16_bf16 v[116:131], v[152:155], v[24:27], v[116:131]
  ds_read_b64_tr_b16 v[152:153], v1 offset:0
  ds_read_b64_tr_b16 v[154:155], v1 offset:256
  v_exp_f32 v160, v160
  v_exp_f32 v161, v161
  v_exp_f32 v162, v162
  s_waitcnt lgkmcnt(4)
  v_mfma_f32_32x32x16_bf16 v[116:131], v[156:159], v[28:31], v[116:131]
  ds_read_b64_tr_b16 v[156:157], v1 offset:2048
  ds_read_b64_tr_b16 v[158:159], v1 offset:2304
  v_exp_f32 v163, v163
  v_add_f32 v160, 1.0, v160
  v_add_f32 v161, 1.0, v161
  v_add_f32 v162, 1.0, v162
  v_add_f32 v163, 1.0, v163
  s_waitcnt lgkmcnt(4)
  v_mfma_f32_32x32x16_bf16 v[116:131], v[148:151], v[32:35], v[116:131]
  s_barrier
  ds_read_b64_tr_b16 v[148:149], v1 offset:4096
  ds_read_b64_tr_b16 v[150:151], v1 offset:4352
  v_rcp_f32 v160, v160
  v_rcp_f32 v161, v161
  v_rcp_f32 v162, v162
  s_waitcnt lgkmcnt(4)
  v_mfma_f32_32x32x16_bf16 v[116:131], v[152:155], v[36:39], v[116:131]
  ds_read_b64_tr_b16 v[152:153], v1 offset:6144
  ds_read_b64_tr_b16 v[154:155], v1 offset:6400
  v_rcp_f32 v163, v163
  v_mul_f32 v132, v132, v160
  v_mul_f32 v133, v133, v161
  v_mul_f32 v134, v134, v162
  v_mul_f32 v135, v135, v163
  s_waitcnt lgkmcnt(4)
  v_mfma_f32_32x32x16_bf16 v[116:131], v[156:159], v[40:43], v[116:131]
  ds_read_b64_tr_b16 v[156:157], v1 offset:8192
  ds_read_b64_tr_b16 v[158:159], v1 offset:8448
  v_mul_f32 v160, s64, v136
  v_mul_f32 v161, s64, v137
  v_mul_f32 v162, s64, v138
  v_mul_f32 v163, s64, v139
  v_fma_f32 v164, v160, v160, s65
  v_fma_f32 v165, v161, v161, s65
  s_waitcnt lgkmcnt(4)
  v_mfma_f32_32x32x16_bf16 v[116:131], v[148:151], v[44:47], v[116:131]
  ds_read_b64_tr_b16 v[148:149], v1 offset:10240
  ds_read_b64_tr_b16 v[150:151], v1 offset:10496
  v_fma_f32 v166, v162, v162, s65
  v_fma_f32 v167, v163, v163, s65
  v_mul_f32 v160, v160, v164
  v_mul_f32 v161, v161, v165
  v_mul_f32 v162, v162, v166
  v_mul_f32 v163, v163, v167
  s_waitcnt lgkmcnt(4)
  v_mfma_f32_32x32x16_bf16 v[116:131], v[152:155], v[48:51], v[116:131]
  ds_read_b64_tr_b16 v[152:153], v1 offset:12288
  ds_read_b64_tr_b16 v[154:155], v1 offset:12544
  v_exp_f32 v160, v160
  v_exp_f32 v161, v161
  v_exp_f32 v162, v162
  s_waitcnt lgkmcnt(4)
  v_mfma_f32_32x32x16_bf16 v[116:131], v[156:159], v[52:55], v[116:131]
  ds_read_b64_tr_b16 v[156:157], v1 offset:14336
  ds_read_b64_tr_b16 v[158:159], v1 offset:14592
  v_add_u32 v1, 114688, v3
  v_exp_f32 v163, v163
  v_add_f32 v160, 1.0, v160
  v_add_f32 v161, 1.0, v161
  v_add_f32 v162, 1.0, v162
  v_add_f32 v163, 1.0, v163
  s_waitcnt lgkmcnt(4)
  v_mfma_f32_32x32x16_bf16 v[116:131], v[148:151], v[56:59], v[116:131]
  ds_read_b64_tr_b16 v[148:149], v2 offset:0
  ds_read_b64_tr_b16 v[150:151], v2 offset:256
  v_rcp_f32 v160, v160
  v_rcp_f32 v161, v161
  v_rcp_f32 v162, v162
  s_waitcnt lgkmcnt(4)
  v_mfma_f32_32x32x16_bf16 v[116:131], v[152:155], v[60:63], v[116:131]
  ds_read_b64_tr_b16 v[152:153], v2 offset:2048
  ds_read_b64_tr_b16 v[154:155], v2 offset:2304
  v_rcp_f32 v163, v163
  v_mul_f32 v136, v136, v160
  v_mul_f32 v137, v137, v161
  v_mul_f32 v138, v138, v162
  v_mul_f32 v139, v139, v163
  s_waitcnt lgkmcnt(4)
  v_mfma_f32_32x32x16_bf16 v[116:131], v[156:159], v[64:67], v[116:131]
  s_barrier
  ds_read_b64_tr_b16 v[156:157], v2 offset:4096
  ds_read_b64_tr_b16 v[158:159], v2 offset:4352
  v_mul_f32 v160, s64, v140
  v_mul_f32 v161, s64, v141
  v_mul_f32 v162, s64, v142
  v_mul_f32 v163, s64, v143
  v_fma_f32 v164, v160, v160, s65
  v_fma_f32 v165, v161, v161, s65
  s_waitcnt lgkmcnt(4)
  v_mfma_f32_32x32x16_bf16 v[116:131], v[148:151], v[68:71], v[116:131]
  ds_read_b64_tr_b16 v[148:149], v2 offset:6144
  ds_read_b64_tr_b16 v[150:151], v2 offset:6400
  v_fma_f32 v166, v162, v162, s65
  v_fma_f32 v167, v163, v163, s65
  v_mul_f32 v160, v160, v164
  v_mul_f32 v161, v161, v165
  v_mul_f32 v162, v162, v166
  v_mul_f32 v163, v163, v167
  s_waitcnt lgkmcnt(4)
  v_mfma_f32_32x32x16_bf16 v[116:131], v[152:155], v[72:75], v[116:131]
  ds_read_b64_tr_b16 v[152:153], v2 offset:8192
  ds_read_b64_tr_b16 v[154:155], v2 offset:8448
  v_exp_f32 v160, v160
  v_exp_f32 v161, v161
  v_exp_f32 v162, v162
  s_waitcnt lgkmcnt(4)
  v_mfma_f32_32x32x16_bf16 v[116:131], v[156:159], v[76:79], v[116:131]
  ds_read_b64_tr_b16 v[156:157], v2 offset:10240
  ds_read_b64_tr_b16 v[158:159], v2 offset:10496
  v_exp_f32 v163, v163
  v_add_f32 v160, 1.0, v160
  v_add_f32 v161, 1.0, v161
  v_add_f32 v162, 1.0, v162
  v_add_f32 v163, 1.0, v163
  s_waitcnt lgkmcnt(4)
  v_mfma_f32_32x32x16_bf16 v[116:131], v[148:151], v[80:83], v[116:131]
  ds_read_b64_tr_b16 v[148:149], v2 offset:12288
  ds_read_b64_tr_b16 v[150:151], v2 offset:12544
  v_rcp_f32 v160, v160
  v_rcp_f32 v161, v161
  v_rcp_f32 v162, v162
  s_waitcnt lgkmcnt(4)
  v_mfma_f32_32x32x16_bf16 v[116:131], v[152:155], v[84:87], v[116:131]
  ds_read_b64_tr_b16 v[152:153], v2 offset:14336
  ds_read_b64_tr_b16 v[154:155], v2 offset:14592
  v_add_u32 v2, 131072, v3
  v_rcp_f32 v163, v163
  v_mul_f32 v140, v140, v160
  v_mul_f32 v141, v141, v161
  v_mul_f32 v142, v142, v162
  v_mul_f32 v143, v143, v163
  s_waitcnt lgkmcnt(4)
  v_mfma_f32_32x32x16_bf16 v[116:131], v[156:159], v[88:91], v[116:131]
  ds_read_b64_tr_b16 v[156:157], v1 offset:0
  ds_read_b64_tr_b16 v[158:159], v1 offset:256
  v_mul_f32 v160, s64, v144
  v_mul_f32 v161, s64, v145
  v_mul_f32 v162, s64, v146
  v_mul_f32 v163, s64, v147
  v_fma_f32 v164, v160, v160, s65
  v_fma_f32 v165, v161, v161, s65
  s_waitcnt lgkmcnt(4)
  v_mfma_f32_32x32x16_bf16 v[116:131], v[148:151], v[92:95], v[116:131]
  ds_read_b64_tr_b16 v[148:149], v1 offset:2048
  ds_read_b64_tr_b16 v[150:151], v1 offset:2304
  v_fma_f32 v166, v162, v162, s65
  v_fma_f32 v167, v163, v163, s65
  v_mul_f32 v160, v160, v164
  v_mul_f32 v161, v161, v165
  v_mul_f32 v162, v162, v166
  v_mul_f32 v163, v163, v167
  s_waitcnt lgkmcnt(4)
  v_mfma_f32_32x32x16_bf16 v[116:131], v[152:155], v[96:99], v[116:131]
  s_waitcnt vmcnt(0)
  s_barrier
  ds_read_b64_tr_b16 v[152:153], v1 offset:4096
  ds_read_b64_tr_b16 v[154:155], v1 offset:4352
  v_exp_f32 v160, v160
  v_exp_f32 v161, v161
  v_exp_f32 v162, v162
  s_waitcnt lgkmcnt(4)
  v_mfma_f32_32x32x16_bf16 v[116:131], v[156:159], v[100:103], v[116:131]
  ds_read_b64_tr_b16 v[156:157], v1 offset:6144
  ds_read_b64_tr_b16 v[158:159], v1 offset:6400
  v_add_u32 v1, 147456, v3
  v_exp_f32 v163, v163
  v_add_f32 v160, 1.0, v160
  v_add_f32 v161, 1.0, v161
  v_add_f32 v162, 1.0, v162
  v_add_f32 v163, 1.0, v163
  s_waitcnt lgkmcnt(4)
  v_mfma_f32_32x32x16_bf16 v[116:131], v[148:151], v[104:107], v[116:131]
  ds_read_b64_tr_b16 v[148:149], v2 offset:0
  ds_read_b64_tr_b16 v[150:151], v2 offset:256
  v_rcp_f32 v160, v160
  v_rcp_f32 v161, v161
  v_rcp_f32 v162, v162
  s_waitcnt lgkmcnt(4)
  v_mfma_f32_32x32x16_bf16 v[116:131], v[152:155], v[108:111], v[116:131]
  ds_read_b64_tr_b16 v[152:153], v2 offset:2048
  ds_read_b64_tr_b16 v[154:155], v2 offset:2304
  v_rcp_f32 v163, v163
  v_mul_f32 v144, v144, v160
  v_mul_f32 v145, v145, v161
  v_mul_f32 v146, v146, v162
  v_mul_f32 v147, v147, v163
  s_waitcnt lgkmcnt(4)
  v_mfma_f32_32x32x16_bf16 v[116:131], v[156:159], v[112:115], v[116:131]
  s_barrier
  ds_read_b64_tr_b16 v[156:157], v2 offset:4096
  ds_read_b64_tr_b16 v[158:159], v2 offset:4352
  s_nop 8
  v_mul_f32 v132, v132, v116
  v_mul_f32 v133, v133, v117
  v_mul_f32 v134, v134, v118
  v_mul_f32 v135, v135, v119
  v_mul_f32 v136, v136, v120
  v_mul_f32 v137, v137, v121
  v_mul_f32 v138, v138, v122
  v_mul_f32 v139, v139, v123
  v_mul_f32 v140, v140, v124
  v_mul_f32 v141, v141, v125
  v_mul_f32 v142, v142, v126
  v_mul_f32 v143, v143, v127
  v_mul_f32 v144, v144, v128
  v_mul_f32 v145, v145, v129
  v_mul_f32 v146, v146, v130
  v_mul_f32 v147, v147, v131
  s_waitcnt lgkmcnt(4)
  v_mfma_f32_32x32x16_bf16 v[116:131], v[148:151], v[4:7], 0
  ds_read_b64_tr_b16 v[148:149], v2 offset:6144
  ds_read_b64_tr_b16 v[150:151], v2 offset:6400
  s_waitcnt lgkmcnt(4)
  v_mfma_f32_32x32x16_bf16 v[116:131], v[152:155], v[8:11], v[116:131]
  ds_read_b64_tr_b16 v[152:153], v2 offset:8192
  ds_read_b64_tr_b16 v[154:155], v2 offset:8448
  v_cvt_pk_bf16_f32 v132, v132, v133
  v_cvt_pk_bf16_f32 v133, v134, v135
  v_cvt_pk_bf16_f32 v134, v136, v137
  s_waitcnt lgkmcnt(4)
  v_mfma_f32_32x32x16_bf16 v[116:131], v[156:159], v[12:15], v[116:131]
  ds_read_b64_tr_b16 v[156:157], v2 offset:10240
  ds_read_b64_tr_b16 v[158:159], v2 offset:10496
  v_cvt_pk_bf16_f32 v135, v138, v139
  v_cvt_pk_bf16_f32 v136, v140, v141
  v_cvt_pk_bf16_f32 v137, v142, v143
  s_waitcnt lgkmcnt(4)
  v_mfma_f32_32x32x16_bf16 v[116:131], v[148:151], v[16:19], v[116:131]
  ds_read_b64_tr_b16 v[148:149], v2 offset:12288
  ds_read_b64_tr_b16 v[150:151], v2 offset:12544
  v_cvt_pk_bf16_f32 v138, v144, v145
  v_cvt_pk_bf16_f32 v139, v146, v147
  s_waitcnt lgkmcnt(4)
  v_mfma_f32_32x32x16_bf16 v[116:131], v[152:155], v[20:23], v[116:131]
  ds_read_b64_tr_b16 v[152:153], v2 offset:14336
  ds_read_b64_tr_b16 v[154:155], v2 offset:14592
  v_add_u32 v2, 0, v3
  buffer_store_dwordx4 v[132:135], v0, s[40:43], s70 offen sc1
  s_waitcnt lgkmcnt(4)
  v_mfma_f32_32x32x16_bf16 v[116:131], v[156:159], v[24:27], v[116:131]
  ds_read_b64_tr_b16 v[156:157], v1 offset:0
  ds_read_b64_tr_b16 v[158:159], v1 offset:256
  buffer_store_dwordx4 v[136:139], v0, s[40:43], s70 offen offset:1024 sc1
  s_waitcnt lgkmcnt(4)
  v_mfma_f32_32x32x16_bf16 v[116:131], v[148:151], v[28:31], v[116:131]
  ds_read_b64_tr_b16 v[148:149], v1 offset:2048
  ds_read_b64_tr_b16 v[150:151], v1 offset:2304
  s_add_u32 s70, s70, 4096
  s_waitcnt lgkmcnt(4)
  v_mfma_f32_32x32x16_bf16 v[116:131], v[152:155], v[32:35], v[116:131]
  s_barrier
  ds_read_b64_tr_b16 v[152:153], v1 offset:4096
  ds_read_b64_tr_b16 v[154:155], v1 offset:4352
  s_waitcnt lgkmcnt(4)
  v_mfma_f32_32x32x16_bf16 v[116:131], v[156:159], v[36:39], v[116:131]
  ds_read_b64_tr_b16 v[156:157], v1 offset:6144
  ds_read_b64_tr_b16 v[158:159], v1 offset:6400
  s_waitcnt lgkmcnt(4)
  v_mfma_f32_32x32x16_bf16 v[116:131], v[148:151], v[40:43], v[116:131]
  ds_read_b64_tr_b16 v[148:149], v1 offset:8192
  ds_read_b64_tr_b16 v[150:151], v1 offset:8448
  s_waitcnt lgkmcnt(4)
  v_mfma_f32_32x32x16_bf16 v[116:131], v[152:155], v[44:47], v[116:131]
  ds_read_b64_tr_b16 v[152:153], v1 offset:10240
  ds_read_b64_tr_b16 v[154:155], v1 offset:10496
  s_waitcnt lgkmcnt(4)
  v_mfma_f32_32x32x16_bf16 v[116:131], v[156:159], v[48:51], v[116:131]
  ds_read_b64_tr_b16 v[156:157], v1 offset:12288
  ds_read_b64_tr_b16 v[158:159], v1 offset:12544
  s_lshr_b32 s7, s6, 4
  s_lshl_b32 s8, s5, 1
  s_waitcnt lgkmcnt(4)
  v_mfma_f32_32x32x16_bf16 v[116:131], v[148:151], v[52:55], v[116:131]
  ds_read_b64_tr_b16 v[148:149], v1 offset:14336
  ds_read_b64_tr_b16 v[150:151], v1 offset:14592
  v_add_u32 v1, 16384, v3
  s_add_u32 s7, s7, s8
  s_and_b32 s8, s6, 15
  s_lshl_b32 s11, s8, 2
  s_waitcnt lgkmcnt(4)
  v_mfma_f32_32x32x16_bf16 v[116:131], v[152:155], v[56:59], v[116:131]
  ds_read_b64_tr_b16 v[152:153], v2 offset:0
  ds_read_b64_tr_b16 v[154:155], v2 offset:256
  s_add_u32 s11, s11, s60
  s_lshl_b32 s9, s7, 18
  s_waitcnt lgkmcnt(4)
  v_mfma_f32_32x32x16_bf16 v[116:131], v[156:159], v[60:63], v[116:131]
  ds_read_b64_tr_b16 v[156:157], v2 offset:2048
  ds_read_b64_tr_b16 v[158:159], v2 offset:2304
  s_add_u32 s9, s9, 2097152
  s_lshl_b32 s46, s61, 14
  s_waitcnt lgkmcnt(4)
  v_mfma_f32_32x32x16_bf16 v[116:131], v[148:151], v[64:67], v[116:131]
  s_barrier
  ds_read_b64_tr_b16 v[148:149], v2 offset:4096
  ds_read_b64_tr_b16 v[150:151], v2 offset:4352
  s_add_u32 s47, s46, 65536
  s_lshl_b32 s13, s60, 12
  s_waitcnt lgkmcnt(4)
  v_mfma_f32_32x32x16_bf16 v[116:131], v[152:155], v[68:71], v[116:131]
  ds_read_b64_tr_b16 v[152:153], v2 offset:6144
  ds_read_b64_tr_b16 v[154:155], v2 offset:6400
  s_add_u32 s14, s46, 65536
  s_lshl_b32 s15, s61, 7
  s_add_u32 s15, s15, 113664
  s_waitcnt lgkmcnt(4)
  v_mfma_f32_32x32x16_bf16 v[116:131], v[156:159], v[72:75], v[116:131]
  ds_read_b64_tr_b16 v[156:157], v2 offset:8192
  ds_read_b64_tr_b16 v[158:159], v2 offset:8448
  s_mov_b32 s48, 1
  s_mov_b32 s49, 0
  s_waitcnt lgkmcnt(4)
  v_mfma_f32_32x32x16_bf16 v[116:131], v[148:151], v[76:79], v[116:131]
  ds_read_b64_tr_b16 v[148:149], v2 offset:10240
  ds_read_b64_tr_b16 v[150:151], v2 offset:10496
  s_mov_b32 s50, 4
  s_mov_b32 s51, 4
  s_waitcnt lgkmcnt(4)
  v_mfma_f32_32x32x16_bf16 v[116:131], v[152:155], v[80:83], v[116:131]
  ds_read_b64_tr_b16 v[152:153], v2 offset:12288
  ds_read_b64_tr_b16 v[154:155], v2 offset:12544
  s_lshl_b32 s10, s60, 11
  s_add_u32 s10, s10, 90112
  s_waitcnt lgkmcnt(4)
  v_mfma_f32_32x32x16_bf16 v[116:131], v[156:159], v[84:87], v[116:131]
  ds_read_b64_tr_b16 v[156:157], v2 offset:14336
  ds_read_b64_tr_b16 v[158:159], v2 offset:14592
  v_add_u32 v2, 32768, v3
  s_add_u32 s36, s34, s9
  s_addc_u32 s37, s35, 0
  s_mov_b32 s38, 262144
  s_waitcnt lgkmcnt(4)
  v_mfma_f32_32x32x16_bf16 v[116:131], v[148:151], v[88:91], v[116:131]
  ds_read_b64_tr_b16 v[148:149], v1 offset:0
  ds_read_b64_tr_b16 v[150:151], v1 offset:256
  s_waitcnt lgkmcnt(4)
  v_mfma_f32_32x32x16_bf16 v[116:131], v[152:155], v[92:95], v[116:131]
  ds_read_b64_tr_b16 v[152:153], v1 offset:2048
  ds_read_b64_tr_b16 v[154:155], v1 offset:2304
  s_waitcnt lgkmcnt(4)
  v_mfma_f32_32x32x16_bf16 v[116:131], v[156:159], v[96:99], v[116:131]
  s_waitcnt vmcnt(0)
  s_barrier
  ds_read_b64_tr_b16 v[156:157], v1 offset:4096
  ds_read_b64_tr_b16 v[158:159], v1 offset:4352
  s_waitcnt lgkmcnt(4)
  v_mfma_f32_32x32x16_bf16 v[116:131], v[148:151], v[100:103], v[116:131]
  ds_read_b64_tr_b16 v[148:149], v1 offset:6144
  ds_read_b64_tr_b16 v[150:151], v1 offset:6400
  v_add_u32 v1, 49152, v3
  s_waitcnt lgkmcnt(4)
  v_mfma_f32_32x32x16_bf16 v[116:131], v[152:155], v[104:107], v[116:131]
  ds_read_b64_tr_b16 v[152:153], v2 offset:0
  ds_read_b64_tr_b16 v[154:155], v2 offset:256
  s_waitcnt lgkmcnt(4)
  v_mfma_f32_32x32x16_bf16 v[116:131], v[156:159], v[108:111], v[116:131]
  ds_read_b64_tr_b16 v[156:157], v2 offset:2048
  ds_read_b64_tr_b16 v[158:159], v2 offset:2304
  s_waitcnt lgkmcnt(4)
  v_mfma_f32_32x32x16_bf16 v[116:131], v[148:151], v[112:115], v[116:131]
  s_barrier
  ds_read_b64_tr_b16 v[148:149], v2 offset:4096
  ds_read_b64_tr_b16 v[150:151], v2 offset:4352
  s_waitcnt lgkmcnt(4)
  v_mfma_f32_32x32x16_bf16 v[132:147], v[152:155], v[4:7], 0
  ds_read_b64_tr_b16 v[152:153], v2 offset:6144
  ds_read_b64_tr_b16 v[154:155], v2 offset:6400
  s_waitcnt lgkmcnt(4)
  v_mfma_f32_32x32x16_bf16 v[132:147], v[156:159], v[8:11], v[132:147]
  ds_read_b64_tr_b16 v[156:157], v2 offset:8192
  ds_read_b64_tr_b16 v[158:159], v2 offset:8448
  s_waitcnt lgkmcnt(4)
  v_mfma_f32_32x32x16_bf16 v[132:147], v[148:151], v[12:15], v[132:147]
  ds_read_b64_tr_b16 v[148:149], v2 offset:10240
  ds_read_b64_tr_b16 v[150:151], v2 offset:10496
  v_mul_f32 v160, s64, v116
  v_mul_f32 v161, s64, v117
  v_mul_f32 v162, s64, v118
  v_mul_f32 v163, s64, v119
  v_fma_f32 v164, v160, v160, s65
  v_fma_f32 v165, v161, v161, s65
  s_waitcnt lgkmcnt(4)
  v_mfma_f32_32x32x16_bf16 v[132:147], v[152:155], v[16:19], v[132:147]
  ds_read_b64_tr_b16 v[152:153], v2 offset:12288
  ds_read_b64_tr_b16 v[154:155], v2 offset:12544
  v_fma_f32 v166, v162, v162, s65
  v_fma_f32 v167, v163, v163, s65
  v_mul_f32 v160, v160, v164
  v_mul_f32 v161, v161, v165
  v_mul_f32 v162, v162, v166
  s_waitcnt lgkmcnt(4)
  v_mfma_f32_32x32x16_bf16 v[132:147], v[156:159], v[20:23], v[132:147]
  ds_read_b64_tr_b16 v[156:157], v2 offset:14336
  ds_read_b64_tr_b16 v[158:159], v2 offset:14592
  v_add_u32 v2, 65536, v3
  v_mul_f32 v163, v163, v167
  v_exp_f32 v160, v160
  v_exp_f32 v161, v161
  s_waitcnt lgkmcnt(4)
  v_mfma_f32_32x32x16_bf16 v[132:147], v[148:151], v[24:27], v[132:147]
  ds_read_b64_tr_b16 v[148:149], v1 offset:0
  ds_read_b64_tr_b16 v[150:151], v1 offset:256
  v_exp_f32 v162, v162
  v_exp_f32 v163, v163
  v_add_f32 v160, 1.0, v160
  v_add_f32 v161, 1.0, v161
  s_waitcnt lgkmcnt(4)
  v_mfma_f32_32x32x16_bf16 v[132:147], v[152:155], v[28:31], v[132:147]
  ds_read_b64_tr_b16 v[152:153], v1 offset:2048
  ds_read_b64_tr_b16 v[154:155], v1 offset:2304
  v_add_f32 v162, 1.0, v162
  v_add_f32 v163, 1.0, v163
  v_rcp_f32 v160, v160
  v_rcp_f32 v161, v161
  s_waitcnt lgkmcnt(4)
  v_mfma_f32_32x32x16_bf16 v[132:147], v[156:159], v[32:35], v[132:147]
  s_barrier
  ds_read_b64_tr_b16 v[156:157], v1 offset:4096
  ds_read_b64_tr_b16 v[158:159], v1 offset:4352
  v_rcp_f32 v162, v162
  v_rcp_f32 v163, v163
  v_mul_f32 v116, v116, v160
  s_waitcnt lgkmcnt(4)
  v_mfma_f32_32x32x16_bf16 v[132:147], v[148:151], v[36:39], v[132:147]
  ds_read_b64_tr_b16 v[148:149], v1 offset:6144
  ds_read_b64_tr_b16 v[150:151], v1 offset:6400
  v_mul_f32 v117, v117, v161
  v_mul_f32 v118, v118, v162
  v_mul_f32 v119, v119, v163
  v_mul_f32 v160, s64, v120
  v_mul_f32 v161, s64, v121
  v_mul_f32 v162, s64, v122
  s_waitcnt lgkmcnt(4)
  v_mfma_f32_32x32x16_bf16 v[132:147], v[152:155], v[40:43], v[132:147]
  ds_read_b64_tr_b16 v[152:153], v1 offset:8192
  ds_read_b64_tr_b16 v[154:155], v1 offset:8448
  v_mul_f32 v163, s64, v123
  v_fma_f32 v164, v160, v160, s65
  v_fma_f32 v165, v161, v161, s65
  v_fma_f32 v166, v162, v162, s65
  v_fma_f32 v167, v163, v163, s65
  s_waitcnt lgkmcnt(4)
  v_mfma_f32_32x32x16_bf16 v[132:147], v[156:159], v[44:47], v[132:147]
  ds_read_b64_tr_b16 v[156:157], v1 offset:10240
  ds_read_b64_tr_b16 v[158:159], v1 offset:10496
  v_mul_f32 v160, v160, v164
  v_mul_f32 v161, v161, v165
  v_mul_f32 v162, v162, v166
  v_mul_f32 v163, v163, v167
  v_exp_f32 v160, v160
  s_waitcnt lgkmcnt(4)
  v_mfma_f32_32x32x16_bf16 v[132:147], v[148:151], v[48:51], v[132:147]
  ds_read_b64_tr_b16 v[148:149], v1 offset:12288
  ds_read_b64_tr_b16 v[150:151], v1 offset:12544
  v_exp_f32 v161, v161
  v_exp_f32 v162, v162
  v_exp_f32 v163, v163
  s_waitcnt lgkmcnt(4)
  v_mfma_f32_32x32x16_bf16 v[132:147], v[152:155], v[52:55], v[132:147]
  ds_read_b64_tr_b16 v[152:153], v1 offset:14336
  ds_read_b64_tr_b16 v[154:155], v1 offset:14592
  v_add_u32 v1, 81920, v3
  v_add_f32 v160, 1.0, v160
  v_add_f32 v161, 1.0, v161
  v_add_f32 v162, 1.0, v162
  v_add_f32 v163, 1.0, v163
  s_waitcnt lgkmcnt(4)
  v_mfma_f32_32x32x16_bf16 v[132:147], v[156:159], v[56:59], v[132:147]
  ds_read_b64_tr_b16 v[156:157], v2 offset:0
  ds_read_b64_tr_b16 v[158:159], v2 offset:256
  v_rcp_f32 v160, v160
  v_rcp_f32 v161, v161
  v_rcp_f32 v162, v162
  s_waitcnt lgkmcnt(4)
  v_mfma_f32_32x32x16_bf16 v[132:147], v[148:151], v[60:63], v[132:147]
  ds_read_b64_tr_b16 v[148:149], v2 offset:2048
  ds_read_b64_tr_b16 v[150:151], v2 offset:2304
  v_rcp_f32 v163, v163
  v_mul_f32 v120, v120, v160
  v_mul_f32 v121, v121, v161
  v_mul_f32 v122, v122, v162
  v_mul_f32 v123, v123, v163
  s_waitcnt lgkmcnt(4)
  v_mfma_f32_32x32x16_bf16 v[132:147], v[152:155], v[64:67], v[132:147]
  s_barrier
  ds_read_b64_tr_b16 v[152:153], v2 offset:4096
  ds_read_b64_tr_b16 v[154:155], v2 offset:4352
  v_mul_f32 v160, s64, v124
  v_mul_f32 v161, s64, v125
  v_mul_f32 v162, s64, v126
  v_mul_f32 v163, s64, v127
  v_fma_f32 v164, v160, v160, s65
  v_fma_f32 v165, v161, v161, s65
  s_waitcnt lgkmcnt(4)
  v_mfma_f32_32x32x16_bf16 v[132:147], v[156:159], v[68:71], v[132:147]
  ds_read_b64_tr_b16 v[156:157], v2 offset:6144
  ds_read_b64_tr_b16 v[158:159], v2 offset:6400
  v_fma_f32 v166, v162, v162, s65
  v_fma_f32 v167, v163, v163, s65
  v_mul_f32 v160, v160, v164
  v_mul_f32 v161, v161, v165
  v_mul_f32 v162, v162, v166
  s_waitcnt lgkmcnt(4)
  v_mfma_f32_32x32x16_bf16 v[132:147], v[148:151], v[72:75], v[132:147]
  ds_read_b64_tr_b16 v[148:149], v2 offset:8192
  ds_read_b64_tr_b16 v[150:151], v2 offset:8448
  v_mul_f32 v163, v163, v167
  v_exp_f32 v160, v160
  v_exp_f32 v161, v161
  s_waitcnt lgkmcnt(4)
  v_mfma_f32_32x32x16_bf16 v[132:147], v[152:155], v[76:79], v[132:147]
  ds_read_b64_tr_b16 v[152:153], v2 offset:10240
  ds_read_b64_tr_b16 v[154:155], v2 offset:10496
  v_exp_f32 v162, v162
  v_exp_f32 v163, v163
  v_add_f32 v160, 1.0, v160
  v_add_f32 v161, 1.0, v161
  s_waitcnt lgkmcnt(4)
  v_mfma_f32_32x32x16_bf16 v[132:147], v[156:159], v[80:83], v[132:147]
  ds_read_b64_tr_b16 v[156:157], v2 offset:12288
  ds_read_b64_tr_b16 v[158:159], v2 offset:12544
  v_add_f32 v162, 1.0, v162
  v_add_f32 v163, 1.0, v163
  v_rcp_f32 v160, v160
  v_rcp_f32 v161, v161
  s_waitcnt lgkmcnt(4)
  v_mfma_f32_32x32x16_bf16 v[132:147], v[148:151], v[84:87], v[132:147]
  ds_read_b64_tr_b16 v[148:149], v2 offset:14336
  ds_read_b64_tr_b16 v[150:151], v2 offset:14592
  v_rcp_f32 v162, v162
  v_rcp_f32 v163, v163
  v_mul_f32 v124, v124, v160
  s_waitcnt lgkmcnt(4)
  v_mfma_f32_32x32x16_bf16 v[132:147], v[152:155], v[88:91], v[132:147]
  ds_read_b64_tr_b16 v[152:153], v1 offset:0
  ds_read_b64_tr_b16 v[154:155], v1 offset:256
  v_mul_f32 v125, v125, v161
  v_mul_f32 v126, v126, v162
  v_mul_f32 v127, v127, v163
  v_mul_f32 v160, s64, v128
  v_mul_f32 v161, s64, v129
  v_mul_f32 v162, s64, v130
  s_waitcnt lgkmcnt(4)
  v_mfma_f32_32x32x16_bf16 v[132:147], v[156:159], v[92:95], v[132:147]
  ds_read_b64_tr_b16 v[156:157], v1 offset:2048
  ds_read_b64_tr_b16 v[158:159], v1 offset:2304
  v_mul_f32 v163, s64, v131
  v_fma_f32 v164, v160, v160, s65
  v_fma_f32 v165, v161, v161, s65
  v_fma_f32 v166, v162, v162, s65
  v_fma_f32 v167, v163, v163, s65
  s_waitcnt lgkmcnt(4)
  v_mfma_f32_32x32x16_bf16 v[132:147], v[148:151], v[96:99], v[132:147]
  s_barrier
  ds_read_b64_tr_b16 v[148:149], v1 offset:4096
  ds_read_b64_tr_b16 v[150:151], v1 offset:4352
  v_mul_f32 v160, v160, v164
  v_mul_f32 v161, v161, v165
  v_mul_f32 v162, v162, v166
  v_mul_f32 v163, v163, v167
  v_exp_f32 v160, v160
  s_waitcnt lgkmcnt(4)
  v_mfma_f32_32x32x16_bf16 v[132:147], v[152:155], v[100:103], v[132:147]
  ds_read_b64_tr_b16 v[152:153], v1 offset:6144
  ds_read_b64_tr_b16 v[154:155], v1 offset:6400
  v_exp_f32 v161, v161
  v_exp_f32 v162, v162
  v_exp_f32 v163, v163
  s_waitcnt lgkmcnt(4)
  v_mfma_f32_32x32x16_bf16 v[132:147], v[156:159], v[104:107], v[132:147]
  v_add_f32 v160, 1.0, v160
  v_add_f32 v161, 1.0, v161
  v_add_f32 v162, 1.0, v162
  v_add_f32 v163, 1.0, v163
  s_waitcnt lgkmcnt(2)
  v_mfma_f32_32x32x16_bf16 v[132:147], v[148:151], v[108:111], v[132:147]
  v_rcp_f32 v160, v160
  v_rcp_f32 v161, v161
  v_rcp_f32 v162, v162
  s_waitcnt lgkmcnt(0)
  v_mfma_f32_32x32x16_bf16 v[132:147], v[152:155], v[112:115], v[132:147]
  v_rcp_f32 v163, v163
  v_mul_f32 v128, v128, v160
  v_mul_f32 v129, v129, v161
  v_mul_f32 v130, v130, v162
  v_mul_f32 v131, v131, v163
  v_mov_b32 v92, 113760
  v_add_u32 v94, s10, v0
  v_add_u32 v1, s46, v0
  v_add_u32 v2, 32768, v1
  s_mov_b32 s52, 32768
L_w0b:
  ds_read_b32 v90, v92
  s_sub_u32 s52, s52, 1
  s_waitcnt lgkmcnt(0)
  v_cmp_ne_u32 vcc, 4, v90
  s_cmp_eq_u32 s52, 0
  s_cbranch_scc1 L_w0b_x
  s_cmp_eq_u64 vcc, 0
  s_cbranch_scc1 L_w0b_x
  s_sleep 1
  s_branch L_w0b
L_w0b_x:
  ds_read_b128 v[8:11], v94
  ds_read_b128 v[12:15], v94 offset:1024
  ds_read_b128 v[16:19], v1
  ds_read_b128 v[20:23], v1 offset:1024
  ds_read_b64 v[100:101], v92 offset:8
  v_add_u32 v5, s13, v0
  v_mov_b32 v6, s15
  v_xor_b32 v4, 128, v6
  v_mov_b32 v88, 1
  v_mov_b32 v89, 0
  s_waitcnt lgkmcnt(0)
  v_mfma_f32_32x32x16_bf16 v[32:47], v[16:19], v[8:11], 0
  v_mfma_f32_32x32x16_bf16 v[32:47], v[20:23], v[12:15], v[32:47]
  ds_read_b128 v[16:19], v1 offset:4096
  ds_read_b128 v[20:23], v1 offset:5120
  ds_read_b128 v[28:31], v1 offset:3072
  ds_read_b128 v[24:27], v1 offset:2048
  v_mul_f32 v132, v132, v116
  v_mul_f32 v133, v133, v117
  v_mul_f32 v134, v134, v118
  v_mul_f32 v135, v135, v119
  v_mul_f32 v136, v136, v120
  v_mul_f32 v137, v137, v121
  v_mul_f32 v138, v138, v122
  v_mul_f32 v139, v139, v123
  v_mul_f32 v140, v140, v124
  v_mul_f32 v141, v141, v125
  v_mul_f32 v142, v142, v126
  v_mul_f32 v143, v143, v127
  v_mul_f32 v144, v144, v128
  v_mul_f32 v145, v145, v129
  v_mul_f32 v146, v146, v130
  v_mul_f32 v147, v147, v131
  s_waitcnt lgkmcnt(2)
  v_mfma_f32_32x32x16_bf16 v[48:63], v[16:19], v[8:11], 0
  ds_read_b128 v[16:19], v1 offset:8192
  v_exp_f32 v32, v32
  v_exp_f32 v33, v33
  s_barrier
  v_cvt_pk_bf16_f32 v132, v132, v133
  v_cvt_pk_bf16_f32 v133, v134, v135
  v_exp_f32 v34, v34
  v_exp_f32 v35, v35
  v_mfma_f32_32x32x16_bf16 v[48:63], v[20:23], v[12:15], v[48:63]
  ds_read_b128 v[20:23], v1 offset:9216
  v_exp_f32 v36, v36
  v_cvt_pk_bf16_f32 v64, v32, v33
  v_exp_f32 v37, v37
  v_cvt_pk_bf16_f32 v65, v34, v35
  v_cvt_pk_bf16_f32 v134, v136, v137
  v_cvt_pk_bf16_f32 v135, v138, v139
  v_exp_f32 v38, v38
  v_exp_f32 v39, v39
  s_waitcnt lgkmcnt(2)
  ds_read_b128 v[28:31], v1 offset:3072
  v_exp_f32 v40, v40
  v_cvt_pk_bf16_f32 v66, v36, v37
  v_exp_f32 v41, v41
  v_cvt_pk_bf16_f32 v67, v38, v39
  v_cvt_pk_bf16_f32 v136, v140, v141
  v_cvt_pk_bf16_f32 v137, v142, v143
  v_exp_f32 v42, v42
  v_exp_f32 v43, v43
  v_mfma_f32_32x32x16_bf16 v[72:87], v[24:27], v[64:67], 0
  ds_read_b128 v[24:27], v1 offset:6144
  v_exp_f32 v96, v44
  v_cvt_pk_bf16_f32 v68, v40, v41
  v_exp_f32 v97, v45
  v_cvt_pk_bf16_f32 v69, v42, v43
  s_mov_b64 exec, 1
  ds_add_u64 v6, v[88:89]
  s_mov_b64 exec, -1
  v_cvt_pk_bf16_f32 v138, v144, v145
  v_cvt_pk_bf16_f32 v139, v146, v147
  v_exp_f32 v98, v46
  v_exp_f32 v99, v47
  s_waitcnt lgkmcnt(2)
  v_mfma_f32_32x32x16_bf16 v[32:47], v[16:19], v[8:11], 0
  ds_read_b128 v[16:19], v1 offset:12288
  v_exp_f32 v48, v48
  v_cvt_pk_bf16_f32 v70, v96, v97
  v_exp_f32 v49, v49
  v_cvt_pk_bf16_f32 v71, v98, v99
  buffer_store_dwordx4 v[132:135], v0, s[40:43], s70 offen sc1
  buffer_store_dwordx4 v[136:139], v0, s[40:43], s70 offen offset:1024 sc1
  s_add_u32 s70, s70, 4096
  v_exp_f32 v50, v50
  v_exp_f32 v51, v51
  v_mfma_f32_32x32x16_bf16 v[32:47], v[20:23], v[12:15], v[32:47]
  ds_read_b128 v[20:23], v1 offset:13312
  v_exp_f32 v52, v52
  v_cvt_pk_bf16_f32 v64, v48, v49
  v_exp_f32 v53, v53
  v_cvt_pk_bf16_f32 v65, v50, v51
  v_exp_f32 v54, v54
  v_exp_f32 v55, v55
  s_waitcnt lgkmcnt(2)
  v_mfma_f32_32x32x16_bf16 v[72:87], v[28:31], v[68:71], v[72:87]
  ds_read_b128 v[28:31], v1 offset:7168
  v_exp_f32 v56, v56
  v_cvt_pk_bf16_f32 v66, v52, v53
  v_exp_f32 v57, v57
  v_cvt_pk_bf16_f32 v67, v54, v55
  ds_read_b64 v[90:91], v6
  ds_read_b32 v92, v4
  v_exp_f32 v58, v58
  v_exp_f32 v59, v59
  v_mfma_f32_32x32x16_bf16 v[72:87], v[24:27], v[64:67], v[72:87]
  ds_read_b128 v[24:27], v1 offset:10240
  v_exp_f32 v96, v60
  v_cvt_pk_bf16_f32 v68, v56, v57
  v_exp_f32 v97, v61
  v_cvt_pk_bf16_f32 v69, v58, v59
  v_exp_f32 v98, v62
  v_exp_f32 v99, v63
  s_waitcnt lgkmcnt(1)
  v_cmp_ne_u64 vcc, s[50:51], v[90:91]
  s_add_u32 m0, s47, s13
  s_cmp_lg_u64 vcc, 0
  s_cbranch_scc1 L_a_spinfb
L_a_gofb:
  v_cmp_eq_u32 vcc, 4, v92
  s_setprio 0
  s_cmp_eq_u64 vcc, 0
  s_cbranch_scc1 L_a_prfb
  s_setprio 1
L_a_prfb:
  buffer_load_dwordx4 v5, s[36:39], s14 offen offset:0 sc1 lds
  buffer_load_dwordx4 v5, s[36:39], s14 offen offset:1024 sc1 lds
  buffer_load_dwordx4 v5, s[36:39], s14 offen offset:2048 sc1 lds
  buffer_load_dwordx4 v5, s[36:39], s14 offen offset:3072 sc1 lds
  s_add_u32 s14, s14, 32768
  s_waitcnt lgkmcnt(2)
  v_mfma_f32_32x32x16_bf16 v[48:63], v[16:19], v[8:11], 0
  ds_read_b128 v[16:19], v2 offset:0
  v_exp_f32 v32, v32
  v_cvt_pk_bf16_f32 v70, v96, v97
  v_exp_f32 v33, v33
  v_cvt_pk_bf16_f32 v71, v98, v99
  v_exp_f32 v34, v34
  v_exp_f32 v35, v35
  v_mfma_f32_32x32x16_bf16 v[48:63], v[20:23], v[12:15], v[48:63]
  ds_read_b128 v[20:23], v2 offset:1024
  v_exp_f32 v36, v36
  v_cvt_pk_bf16_f32 v64, v32, v33
  v_exp_f32 v37, v37
  v_cvt_pk_bf16_f32 v65, v34, v35
  v_exp_f32 v38, v38
  v_exp_f32 v39, v39
  s_waitcnt lgkmcnt(2)
  v_mfma_f32_32x32x16_bf16 v[72:87], v[28:31], v[68:71], v[72:87]
  ds_read_b128 v[28:31], v1 offset:11264
  v_exp_f32 v40, v40
  v_cvt_pk_bf16_f32 v66, v36, v37
  v_exp_f32 v41, v41
  v_cvt_pk_bf16_f32 v67, v38, v39
  v_exp_f32 v42, v42
  v_exp_f32 v43, v43
  v_mfma_f32_32x32x16_bf16 v[72:87], v[24:27], v[64:67], v[72:87]
  ds_read_b128 v[24:27], v1 offset:14336
  v_exp_f32 v96, v44
  v_cvt_pk_bf16_f32 v68, v40, v41
  v_exp_f32 v97, v45
  v_cvt_pk_bf16_f32 v69, v42, v43
  v_exp_f32 v98, v46
  v_exp_f32 v99, v47
  s_waitcnt lgkmcnt(2)
  v_mfma_f32_32x32x16_bf16 v[32:47], v[16:19], v[8:11], 0
  ds_read_b128 v[16:19], v2 offset:4096
  v_exp_f32 v48, v48
  v_cvt_pk_bf16_f32 v70, v96, v97
  v_exp_f32 v49, v49
  v_cvt_pk_bf16_f32 v71, v98, v99
  v_exp_f32 v50, v50
  v_exp_f32 v51, v51
  v_mfma_f32_32x32x16_bf16 v[32:47], v[20:23], v[12:15], v[32:47]
  ds_read_b128 v[20:23], v2 offset:5120
  v_exp_f32 v52, v52
  v_cvt_pk_bf16_f32 v64, v48, v49
  v_exp_f32 v53, v53
  v_cvt_pk_bf16_f32 v65, v50, v51
  v_exp_f32 v54, v54
  v_exp_f32 v55, v55
  s_waitcnt lgkmcnt(2)
  v_mfma_f32_32x32x16_bf16 v[72:87], v[28:31], v[68:71], v[72:87]
  ds_read_b128 v[28:31], v1 offset:15360
  v_exp_f32 v56, v56
  v_cvt_pk_bf16_f32 v66, v52, v53
  v_exp_f32 v57, v57
  v_cvt_pk_bf16_f32 v67, v54, v55
  v_exp_f32 v58, v58
  v_exp_f32 v59, v59
  v_mfma_f32_32x32x16_bf16 v[72:87], v[24:27], v[64:67], v[72:87]
  ds_read_b128 v[24:27], v2 offset:2048
  v_exp_f32 v96, v60
  v_cvt_pk_bf16_f32 v68, v56, v57
  v_exp_f32 v97, v61
  v_cvt_pk_bf16_f32 v69, v58, v59
  v_mov_b32 v1, v2
  v_add_u32 v2, s47, v0
  v_add_u32 v6, 8, v6
  v_xor_b32 v4, 128, v6
  s_add_u32 s47, s47, 32768
  s_cmp_ge_u32 s47, 98304
  s_cselect_b32 s3, 98304, 0
  s_sub_u32 s47, s47, s3
  s_mov_b64 exec, 1
  v_mov_b32 v92, 113764
  s_waitcnt vmcnt(4)
  ds_add_rtn_u32 v90, v92, v88
  s_waitcnt lgkmcnt(0)
  v_cmp_eq_u32 vcc, 7, v90
  s_nop 0
  s_and_b64 exec, exec, vcc
  s_cbranch_execz L_nhfb
  buffer_store_dwordx2 v[100:101], off, s[40:43], s73 sc1
L_nhfb:
  s_mov_b64 exec, -1
  v_mov_b32 v89, 1
  v_exp_f32 v98, v62
  v_exp_f32 v99, v63
.p2align 6
L_aloop:
  s_waitcnt lgkmcnt(2)
  v_mfma_f32_32x32x16_bf16 v[48:63], v[16:19], v[8:11], 0
  ds_read_b128 v[16:19], v1 offset:8192
  v_exp_f32 v32, v32
  v_cvt_pk_bf16_f32 v70, v96, v97
  v_exp_f32 v33, v33
  v_cvt_pk_bf16_f32 v71, v98, v99
  v_exp_f32 v34, v34
  v_exp_f32 v35, v35
  v_mfma_f32_32x32x16_bf16 v[48:63], v[20:23], v[12:15], v[48:63]
  ds_read_b128 v[20:23], v1 offset:9216
  v_exp_f32 v36, v36
  v_cvt_pk_bf16_f32 v64, v32, v33
  v_exp_f32 v37, v37
  v_cvt_pk_bf16_f32 v65, v34, v35
  v_exp_f32 v38, v38
  v_exp_f32 v39, v39
  s_waitcnt lgkmcnt(2)
  v_mfma_f32_32x32x16_bf16 v[72:87], v[28:31], v[68:71], v[72:87]
  ds_read_b128 v[28:31], v1 offset:3072
  v_exp_f32 v40, v40
  v_cvt_pk_bf16_f32 v66, v36, v37
  v_exp_f32 v41, v41
  v_cvt_pk_bf16_f32 v67, v38, v39
  v_exp_f32 v42, v42
  v_exp_f32 v43, v43
  v_mfma_f32_32x32x16_bf16 v[72:87], v[24:27], v[64:67], v[72:87]
  ds_read_b128 v[24:27], v1 offset:6144
  v_exp_f32 v96, v44
  v_cvt_pk_bf16_f32 v68, v40, v41
  v_exp_f32 v97, v45
  v_cvt_pk_bf16_f32 v69, v42, v43
  s_mov_b64 exec, 1
  s_waitcnt vmcnt(0)
  ds_add_u64 v6, v[88:89]
  s_mov_b64 exec, -1
  v_exp_f32 v98, v46
  v_exp_f32 v99, v47
  s_waitcnt lgkmcnt(2)
  v_mfma_f32_32x32x16_bf16 v[32:47], v[16:19], v[8:11], 0
  ds_read_b128 v[16:19], v1 offset:12288
  v_exp_f32 v48, v48
  v_cvt_pk_bf16_f32 v70, v96, v97
  v_exp_f32 v49, v49
  v_cvt_pk_bf16_f32 v71, v98, v99
  v_exp_f32 v50, v50
  v_exp_f32 v51, v51
  v_mfma_f32_32x32x16_bf16 v[32:47], v[20:23], v[12:15], v[32:47]
  ds_read_b128 v[20:23], v1 offset:13312
  v_exp_f32 v52, v52
  v_cvt_pk_bf16_f32 v64, v48, v49
  v_exp_f32 v53, v53
  v_cvt_pk_bf16_f32 v65, v50, v51
  v_exp_f32 v54, v54
  v_exp_f32 v55, v55
  s_waitcnt lgkmcnt(2)
  v_mfma_f32_32x32x16_bf16 v[72:87], v[28:31], v[68:71], v[72:87]
  ds_read_b128 v[28:31], v1 offset:7168
  v_exp_f32 v56, v56
  v_cvt_pk_bf16_f32 v66, v52, v53
  v_exp_f32 v57, v57
  v_cvt_pk_bf16_f32 v67, v54, v55
  ds_read_b64 v[90:91], v6
  ds_read_b32 v92, v4
  v_exp_f32 v58, v58
  v_exp_f32 v59, v59
  v_mfma_f32_32x32x16_bf16 v[72:87], v[24:27], v[64:67], v[72:87]
  ds_read_b128 v[24:27], v1 offset:10240
  v_exp_f32 v96, v60
  v_cvt_pk_bf16_f32 v68, v56, v57
  v_exp_f32 v97, v61
  v_cvt_pk_bf16_f32 v69, v58, v59
  v_exp_f32 v98, v62
  v_exp_f32 v99, v63
  s_waitcnt lgkmcnt(1)
  v_cmp_ne_u64 vcc, s[50:51], v[90:91]
  s_add_u32 m0, s47, s13
  s_cmp_lg_u64 vcc, 0
  s_cbranch_scc1 L_a_spin
L_a_go:
  v_cmp_eq_u32 vcc, 4, v92
  s_setprio 0
  s_cmp_eq_u64 vcc, 0
  s_cbranch_scc1 L_a_pr
  s_setprio 1
L_a_pr:
  s_cmp_gt_u32 s48, 5
  s_cbranch_scc1 L_a_nofill
  buffer_load_dwordx4 v5, s[36:39], s14 offen offset:0 sc1 lds
  buffer_load_dwordx4 v5, s[36:39], s14 offen offset:1024 sc1 lds
  buffer_load_dwordx4 v5, s[36:39], s14 offen offset:2048 sc1 lds
  buffer_load_dwordx4 v5, s[36:39], s14 offen offset:3072 sc1 lds
  s_add_u32 s14, s14, 32768
L_a_nofill:
  s_waitcnt lgkmcnt(2)
  v_mfma_f32_32x32x16_bf16 v[48:63], v[16:19], v[8:11], 0
  ds_read_b128 v[16:19], v2 offset:0
  v_exp_f32 v32, v32
  v_cvt_pk_bf16_f32 v70, v96, v97
  v_exp_f32 v33, v33
  v_cvt_pk_bf16_f32 v71, v98, v99
  v_exp_f32 v34, v34
  v_exp_f32 v35, v35
  v_mfma_f32_32x32x16_bf16 v[48:63], v[20:23], v[12:15], v[48:63]
  ds_read_b128 v[20:23], v2 offset:1024
  v_exp_f32 v36, v36
  v_cvt_pk_bf16_f32 v64, v32, v33
  v_exp_f32 v37, v37
  v_cvt_pk_bf16_f32 v65, v34, v35
  v_exp_f32 v38, v38
  v_exp_f32 v39, v39
  s_waitcnt lgkmcnt(2)
  v_mfma_f32_32x32x16_bf16 v[72:87], v[28:31], v[68:71], v[72:87]
  ds_read_b128 v[28:31], v1 offset:11264
  v_exp_f32 v40, v40
  v_cvt_pk_bf16_f32 v66, v36, v37
  v_exp_f32 v41, v41
  v_cvt_pk_bf16_f32 v67, v38, v39
  v_exp_f32 v42, v42
  v_exp_f32 v43, v43
  v_mfma_f32_32x32x16_bf16 v[72:87], v[24:27], v[64:67], v[72:87]
  ds_read_b128 v[24:27], v1 offset:14336
  v_exp_f32 v96, v44
  v_cvt_pk_bf16_f32 v68, v40, v41
  v_exp_f32 v97, v45
  v_cvt_pk_bf16_f32 v69, v42, v43
  v_exp_f32 v98, v46
  v_exp_f32 v99, v47
  s_waitcnt lgkmcnt(2)
  v_mfma_f32_32x32x16_bf16 v[32:47], v[16:19], v[8:11], 0
  ds_read_b128 v[16:19], v2 offset:4096
  v_exp_f32 v48, v48
  v_cvt_pk_bf16_f32 v70, v96, v97
  v_exp_f32 v49, v49
  v_cvt_pk_bf16_f32 v71, v98, v99
  v_exp_f32 v50, v50
  v_exp_f32 v51, v51
  v_mfma_f32_32x32x16_bf16 v[32:47], v[20:23], v[12:15], v[32:47]
  ds_read_b128 v[20:23], v2 offset:5120
  v_exp_f32 v52, v52
  v_cvt_pk_bf16_f32 v64, v48, v49
  v_exp_f32 v53, v53
  v_cvt_pk_bf16_f32 v65, v50, v51
  v_exp_f32 v54, v54
  v_exp_f32 v55, v55
  s_waitcnt lgkmcnt(2)
  v_mfma_f32_32x32x16_bf16 v[72:87], v[28:31], v[68:71], v[72:87]
  ds_read_b128 v[28:31], v1 offset:15360
  v_exp_f32 v56, v56
  v_cvt_pk_bf16_f32 v66, v52, v53
  v_exp_f32 v57, v57
  v_cvt_pk_bf16_f32 v67, v54, v55
  v_exp_f32 v58, v58
  v_exp_f32 v59, v59
  v_mfma_f32_32x32x16_bf16 v[72:87], v[24:27], v[64:67], v[72:87]
  ds_read_b128 v[24:27], v2 offset:2048
  v_exp_f32 v96, v60
  v_cvt_pk_bf16_f32 v68, v56, v57
  v_exp_f32 v97, v61
  v_cvt_pk_bf16_f32 v69, v58, v59
  v_mov_b32 v1, v2
  v_add_u32 v2, s47, v0
  v_add_u32 v6, 8, v6
  v_xor_b32 v4, 128, v6
  s_add_u32 s47, s47, 32768
  s_cmp_ge_u32 s47, 98304
  s_cselect_b32 s3, 98304, 0
  s_sub_u32 s47, s47, s3
  s_add_u32 s48, s48, 1
  s_cmp_lt_u32 s48, 8
  v_exp_f32 v98, v62
  v_exp_f32 v99, v63
  s_cbranch_scc1 L_aloop
  s_branch L_a_done
L_a_spinfa:
  s_mov_b32 s52, 32768
L_a_spfa:
  ds_read_b64 v[90:91], v6
  s_sub_u32 s52, s52, 1
  s_waitcnt lgkmcnt(0)
  v_cmp_ne_u64 vcc, s[50:51], v[90:91]
  s_cmp_eq_u32 s52, 0
  s_cbranch_scc1 L_a_spfa_x
  s_cmp_eq_u64 vcc, 0
  s_cbranch_scc1 L_a_spfa_x
  s_sleep 1
  s_branch L_a_spfa
L_a_spfa_x:
  s_branch L_a_gofa
L_a_spinfb:
  s_mov_b32 s52, 32768
L_a_spfb:
  ds_read_b64 v[90:91], v6
  s_sub_u32 s52, s52, 1
  s_waitcnt lgkmcnt(0)
  v_cmp_ne_u64 vcc, s[50:51], v[90:91]
  s_cmp_eq_u32 s52, 0
  s_cbranch_scc1 L_a_spfb_x
  s_cmp_eq_u64 vcc, 0
  s_cbranch_scc1 L_a_spfb_x
  s_sleep 1
  s_branch L_a_spfb
L_a_spfb_x:
  s_branch L_a_gofb
L_a_spin:
  s_mov_b32 s52, 32768
L_a_sp:
  ds_read_b64 v[90:91], v6
  s_sub_u32 s52, s52, 1
  s_waitcnt lgkmcnt(0)
  v_cmp_ne_u64 vcc, s[50:51], v[90:91]
  s_cmp_eq_u32 s52, 0
  s_cbranch_scc1 L_a_sp_x
  s_cmp_eq_u64 vcc, 0
  s_cbranch_scc1 L_a_sp_x
  s_sleep 1
  s_branch L_a_sp
L_a_sp_x:
  s_branch L_a_go
L_a_done:
  v_cvt_pk_bf16_f32 v70, v96, v97
  v_cvt_pk_bf16_f32 v71, v98, v99
  s_waitcnt lgkmcnt(0)
  s_nop 0
  v_mfma_f32_32x32x16_bf16 v[72:87], v[28:31], v[68:71], v[72:87]
  s_lshl_b32 s46, s60, 12
  s_lshl_b32 s3, s61, 14
  s_add_u32 s46, s46, s3
  v_add_u32 v3, s46, v0
  s_lshl_b32 s3, s60, 3
  s_add_u32 s3, s3, 113728
  v_mov_b32 v6, s3
  s_mov_b64 exec, 1
  ds_add_rtn_u32 v90, v6, v88
  s_mov_b64 exec, -1
  s_waitcnt lgkmcnt(0)
  v_readfirstlane_b32 s3, v90
  s_nop 0
  s_cmp_lg_u32 s3, 0
  s_cbranch_scc1 L_acomb
  ds_write_b128 v3, v[72:75] offset:0
  ds_write_b128 v3, v[76:79] offset:1024
  ds_write_b128 v3, v[80:83] offset:2048
  ds_write_b128 v3, v[84:87] offset:3072
  s_mov_b64 exec, 1
  s_waitcnt lgkmcnt(0)
  ds_add_u32 v6, v88 offset:4
  s_waitcnt lgkmcnt(0)
  s_endpgm
L_acomb:
  v_xor_b32 v3, 16384, v3
  s_mov_b32 s52, 32768
L_cw:
  ds_read_b32 v90, v6 offset:4
  s_sub_u32 s52, s52, 1
  s_waitcnt lgkmcnt(0)
  v_cmp_ne_u32 vcc, 1, v90
  s_cmp_eq_u32 s52, 0
  s_cbranch_scc1 L_cw_x
  s_cmp_eq_u64 vcc, 0
  s_cbranch_scc1 L_cw_x
  s_sleep 1
  s_branch L_cw
L_cw_x:
  ds_read_b128 v[32:35], v3 offset:0
  ds_read_b128 v[36:39], v3 offset:1024
  ds_read_b128 v[40:43], v3 offset:2048
  ds_read_b128 v[44:47], v3 offset:3072
  s_waitcnt lgkmcnt(3)
  v_add_f32 v72, v72, v32
  v_add_f32 v73, v73, v33
  v_add_f32 v74, v74, v34
  v_add_f32 v75, v75, v35
  s_waitcnt lgkmcnt(2)
  v_add_f32 v76, v76, v36
  v_add_f32 v77, v77, v37
  v_add_f32 v78, v78, v38
  v_add_f32 v79, v79, v39
  s_waitcnt lgkmcnt(1)
  v_add_f32 v80, v80, v40
  v_add_f32 v81, v81, v41
  v_add_f32 v82, v82, v42
  v_add_f32 v83, v83, v43
  s_waitcnt lgkmcnt(0)
  v_add_f32 v84, v84, v44
  v_add_f32 v85, v85, v45
  v_add_f32 v86, v86, v46
  v_add_f32 v87, v87, v47
L_afin:
  s_mov_b32 s50, 0x2b800000
  s_mov_b32 s51, 0x71800000
  s_bitcmp1_b32 s7, 0
  s_cbranch_scc1 L_f_odd
  s_nop 3
  v_mov_b32 v48, v84
  v_mov_b32 v49, v84
  s_nop 1
  v_permlane32_swap_b32 v48, v49
  s_mov_b32 exec_lo, 0
  v_mov_b32 v84, 0
  v_mov_b32 v85, 0
  v_mov_b32 v86, 0
  v_mov_b32 v87, 0
  s_branch L_f_join
L_f_odd:
  s_nop 3
  v_mov_b32 v48, v72
  v_mov_b32 v49, v72
  s_nop 1
  v_permlane32_swap_b32 v49, v48
  s_mov_b32 exec_hi, 0
  v_mov_b32 v72, 0
  v_mov_b32 v73, 0
  v_mov_b32 v74, 0
  v_mov_b32 v75, 0
L_f_join:
  s_mov_b64 exec, -1
  v_rcp_f32 v50, v49
  v_cmp_ge_f32 s[52:53], v49, s50
  v_cmp_le_f32 s[54:55], v49, s51
  v_mul_f32 v72, v72, v50
  v_mul_f32 v73, v73, v50
  v_mul_f32 v74, v74, v50
  v_mul_f32 v75, v75, v50
  v_mul_f32 v76, v76, v50
  v_mul_f32 v77, v77, v50
  v_mul_f32 v78, v78, v50
  v_mul_f32 v79, v79, v50
  v_mul_f32 v80, v80, v50
  v_mul_f32 v81, v81, v50
  v_mul_f32 v82, v82, v50
  v_mul_f32 v83, v83, v50
  v_mul_f32 v84, v84, v50
  v_mul_f32 v85, v85, v50
  v_mul_f32 v86, v86, v50
  v_mul_f32 v87, v87, v50
  v_mul_f32 v51, 0, v72
  v_fmac_f32 v51, 0, v73
  v_fmac_f32 v51, 0, v74
  v_fmac_f32 v51, 0, v75
  v_fmac_f32 v51, 0, v76
  v_fmac_f32 v51, 0, v77
  v_fmac_f32 v51, 0, v78
  v_fmac_f32 v51, 0, v79
  v_fmac_f32 v51, 0, v80
  v_fmac_f32 v51, 0, v81
  v_fmac_f32 v51, 0, v82
  v_fmac_f32 v51, 0, v83
  v_fmac_f32 v51, 0, v84
  v_fmac_f32 v51, 0, v85
  v_fmac_f32 v51, 0, v86
  v_fmac_f32 v51, 0, v87
  v_cvt_pk_bf16_f32 v64, v72, v73
  v_cvt_pk_bf16_f32 v65, v74, v75
  v_cvt_pk_bf16_f32 v66, v76, v77
  v_cvt_pk_bf16_f32 v67, v78, v79
  v_cvt_pk_bf16_f32 v68, v80, v81
  v_cvt_pk_bf16_f32 v69, v82, v83
  v_cvt_pk_bf16_f32 v70, v84, v85
  v_cvt_pk_bf16_f32 v71, v86, v87
  v_cmp_eq_f32 s[56:57], 0, v51
  s_and_b64 s[52:53], s[52:53], s[54:55]
  s_lshl_b32 s45, s11, 15
  s_lshl_b32 s46, s7, 11
  s_add_u32 s45, s45, s46
  s_add_u32 s45, s45, 13631488
  s_and_b64 s[52:53], s[52:53], s[56:57]
  s_cmp_eq_u64 s[52:53], -1
  s_cbranch_scc1 L_aok
  s_cmp_eq_u32 s49, 0x5afe
  s_cbranch_scc0 L_fallback
L_aok:
  buffer_store_dwordx4 v[64:67], v0, s[40:43], s45 offen sc1
  buffer_store_dwordx4 v[68:71], v0, s[40:43], s45 offen offset:1024 sc1
  s_lshl_b32 s45, s11, 11
  s_lshl_b32 s46, s7, 7
  s_add_u32 s45, s45, s46
  s_add_u32 s45, s45, 17956864
  s_mov_b64 exec, 1
  s_waitcnt vmcnt(0)
  buffer_store_dwordx2 v[100:101], off, s[40:43], s45 sc1
  s_endpgm
L_fallback:
  s_mov_b32 s49, 0x5afe
  v_mov_b32 v72, 0
  v_mov_b32 v73, 0
  v_mov_b32 v74, 0
  v_mov_b32 v75, 0
  v_mov_b32 v76, 0
  v_mov_b32 v77, 0
  v_mov_b32 v78, 0
  v_mov_b32 v79, 0
  v_mov_b32 v80, 0
  v_mov_b32 v81, 0
  v_mov_b32 v82, 0
  v_mov_b32 v83, 0
  v_mov_b32 v84, 0
  v_mov_b32 v85, 0
  v_mov_b32 v86, 0
  v_mov_b32 v87, 0
  v_mov_b32 v104, 0xff800000
  s_mov_b32 s14, 0
L_fbloop:
  buffer_load_dwordx4 v[16:19], v0, s[36:39], s14 offen sc1
  buffer_load_dwordx4 v[20:23], v0, s[36:39], s14 offen offset:1024 sc1
  buffer_load_dwordx4 v[24:27], v0, s[36:39], s14 offen offset:2048 sc1
  buffer_load_dwordx4 v[28:31], v0, s[36:39], s14 offen offset:3072 sc1
  s_waitcnt vmcnt(2)
  v_mfma_f32_32x32x16_bf16 v[32:47], v[16:19], v[8:11], 0
  v_mfma_f32_32x32x16_bf16 v[32:47], v[20:23], v[12:15], v[32:47]
  s_nop 11
  v_max3_f32 v107, v32, v33, v34
  v_max3_f32 v107, v35, v36, v107
  v_max3_f32 v107, v37, v38, v107
  v_max3_f32 v107, v39, v40, v107
  v_max3_f32 v107, v41, v42, v107
  v_max3_f32 v107, v43, v44, v107
  v_max3_f32 v107, v45, v46, v107
  v_max_f32 v107, v47, v107
  v_mov_b32 v108, v107
  s_nop 1
  v_permlane32_swap_b32 v107, v108
  v_max3_f32 v105, v107, v108, v104
  v_sub_f32 v106, v104, v105
  v_exp_f32 v106, v106
  v_mov_b32 v104, v105
  v_sub_f32 v32, v32, v105
  v_sub_f32 v33, v33, v105
  v_sub_f32 v34, v34, v105
  v_sub_f32 v35, v35, v105
  v_sub_f32 v36, v36, v105
  v_sub_f32 v37, v37, v105
  v_sub_f32 v38, v38, v105
  v_sub_f32 v39, v39, v105
  v_sub_f32 v40, v40, v105
  v_sub_f32 v41, v41, v105
  v_sub_f32 v42, v42, v105
  v_sub_f32 v43, v43, v105
  v_sub_f32 v44, v44, v105
  v_sub_f32 v45, v45, v105
  v_sub_f32 v46, v46, v105
  v_sub_f32 v47, v47, v105
  v_exp_f32 v32, v32
  v_exp_f32 v33, v33
  v_exp_f32 v34, v34
  v_exp_f32 v35, v35
  v_exp_f32 v36, v36
  v_exp_f32 v37, v37
  v_exp_f32 v38, v38
  v_exp_f32 v39, v39
  v_exp_f32 v40, v40
  v_exp_f32 v41, v41
  v_exp_f32 v42, v42
  v_exp_f32 v43, v43
  v_exp_f32 v44, v44
  v_exp_f32 v45, v45
  v_exp_f32 v46, v46
  v_exp_f32 v47, v47
  v_mul_f32 v72, v72, v106
  v_mul_f32 v73, v73, v106
  v_mul_f32 v74, v74, v106
  v_mul_f32 v75, v75, v106
  v_mul_f32 v76, v76, v106
  v_mul_f32 v77, v77, v106
  v_mul_f32 v78, v78, v106
  v_mul_f32 v79, v79, v106
  v_mul_f32 v80, v80, v106
  v_mul_f32 v81, v81, v106
  v_mul_f32 v82, v82, v106
  v_mul_f32 v83, v83, v106
  v_mul_f32 v84, v84, v106
  v_mul_f32 v85, v85, v106
  v_mul_f32 v86, v86, v106
  v_mul_f32 v87, v87, v106
  v_cvt_pk_bf16_f32 v64, v32, v33
  v_cvt_pk_bf16_f32 v65, v34, v35
  v_cvt_pk_bf16_f32 v66, v36, v37
  v_cvt_pk_bf16_f32 v67, v38, v39
  v_cvt_pk_bf16_f32 v68, v40, v41
  v_cvt_pk_bf16_f32 v69, v42, v43
  v_cvt_pk_bf16_f32 v70, v44, v45
  v_cvt_pk_bf16_f32 v71, v46, v47
  s_waitcnt vmcnt(0)
  v_mfma_f32_32x32x16_bf16 v[72:87], v[24:27], v[64:67], v[72:87]
  v_mfma_f32_32x32x16_bf16 v[72:87], v[28:31], v[68:71], v[72:87]
  s_add_u32 s14, s14, 4096
  s_cmp_lt_u32 s14, 262144
  s_cbranch_scc1 L_fbloop
  s_branch L_afin
L_service:
  s_sub_u32 s4, s59, 8
  s_and_b32 s9, s4, 1
  s_lshr_b32 s10, s4, 1
  v_bfe_u32 v13, v0, 2, 3
  s_lshl_b32 s12, s4, 3
  v_add_u32 v13, s12, v13
  v_lshrrev_b32 v14, 5, v0
  v_and_b32 v15, 3, v0
  v_lshlrev_b32 v15, 4, v15
  v_mul_u32_u24 v3, 3584, v13
  v_add_u32 v3, v3, v15
  v_lshl_add_u32 v3, v14, 6, v3
  v_mul_u32_u24 v2, 2688, v13
  v_mul_u32_u24 v14, 48, v14
  v_add3_u32 v2, v2, v14, v15
  v_lshrrev_b32 v7, 2, v0
  s_lshl_b32 s12, s10, 4
  v_add_u32 v7, s12, v7
  v_mul_u32_u24 v7, 3584, v7
  v_add_u32 v7, v7, v15
  v_lshlrev_b32 v1, 4, v0
  s_lshl_b32 s56, s4, 10
  s_mul_i32 s64, s7, 112
  s_add_u32 s65, s64, 896
  s_cmp_eq_u32 s8, 1
  s_cselect_b32 s12, 0, 1792
  s_cselect_b32 s13, 0, 256
  s_add_u32 s64, s64, s12
  s_mul_i32 s66, s7, 384
  s_add_u32 s66, s66, s13
  s_lshl_b32 s67, s7, 6
  s_add_u32 s67, s67, 3072
L_ld_p:
  s_sub_u32 s12, s4, 1
  s_cmp_gt_u32 s12, 1
  s_cbranch_scc1 L_nocpf
  s_lshl_b32 s12, s12, 5
  s_add_u32 s12, s12, s6
  s_lshl_b32 s12, s12, 10
  s_cmp_ge_u32 s12, L_code_end-recurrent_scan__mha_block__geglu_ffn__prompt_kernel-1024
  s_cbranch_scc1 L_nocpf
  s_getpc_b64 s[14:15]
L_pcref:
  s_sub_u32 s14, s14, L_pcref-recurrent_scan__mha_block__geglu_ffn__prompt_kernel
  s_subb_u32 s15, s15, 0
  s_add_u32 s14, s14, s12
  s_addc_u32 s15, s15, 0
  global_load_dwordx4 v[48:51], v1, s[14:15]
L_nocpf:
  s_waitcnt lgkmcnt(0)
  s_mov_b32 s36, s18
  s_mov_b32 s37, s19
  s_mov_b32 s38, 1204224
  s_mov_b32 s39, 0x20000
  s_mov_b32 s40, s24
  s_mov_b32 s41, s25
  s_mov_b32 s42, 1605632
  s_mov_b32 s43, 0x20000
  s_cmp_eq_u32 s8, 1
  s_cbranch_scc1 L_ld_b
  s_add_u32 m0, s56, 114688
  s_add_u32 s13, s64, 0
  buffer_load_dwordx4 v2, s[36:39], s13 offen lds
  s_add_u32 m0, s56, 118784
  s_add_u32 s13, s64, 86016
  buffer_load_dwordx4 v2, s[36:39], s13 offen lds
  s_add_u32 m0, s56, 122880
  s_add_u32 s13, s65, 0
  buffer_load_dwordx4 v2, s[36:39], s13 offen lds
  s_add_u32 m0, s56, 126976
  s_add_u32 s13, s65, 86016
  buffer_load_dwordx4 v2, s[36:39], s13 offen lds
  s_add_u32 m0, s56, 131072
  s_add_u32 s13, s64, 172032
  buffer_load_dwordx4 v2, s[36:39], s13 offen lds
  s_add_u32 m0, s56, 135168
  s_add_u32 s13, s64, 258048
  buffer_load_dwordx4 v2, s[36:39], s13 offen lds
  s_add_u32 m0, s56, 139264
  s_add_u32 s13, s65, 172032
  buffer_load_dwordx4 v2, s[36:39], s13 offen lds
  s_add_u32 m0, s56, 143360
  s_add_u32 s13, s65, 258048
  buffer_load_dwordx4 v2, s[36:39], s13 offen lds
  s_add_u32 m0, s56, 147456
  s_add_u32 s13, s64, 344064
  buffer_load_dwordx4 v2, s[36:39], s13 offen lds
  s_add_u32 m0, s56, 151552
  s_add_u32 s13, s64, 430080
  buffer_load_dwordx4 v2, s[36:39], s13 offen lds
  s_add_u32 m0, s56, 155648
  s_add_u32 s13, s65, 344064
  buffer_load_dwordx4 v2, s[36:39], s13 offen lds
  s_cmp_lg_u32 s4, 0
  s_cbranch_scc1 L_notlbVKGUS
  v_min_u32 v44, 8, v0
  v_lshlrev_b32 v44, 21, v44
  v_mov_b32 v45, s35
  v_add_co_u32 v44, vcc, s34, v44
  s_nop 1
  v_addc_co_u32 v45, vcc, 0, v45, vcc
  v_writelane_b32 v44, s24, 16
  v_writelane_b32 v45, s25, 16
  s_add_u32 s12, s24, 1605628
  s_addc_u32 s13, s25, 0
  v_writelane_b32 v44, s12, 17
  v_writelane_b32 v45, s13, 17
  v_writelane_b32 v44, s26, 18
  v_writelane_b32 v45, s27, 18
  s_add_u32 s12, s26, 1605628
  s_addc_u32 s13, s27, 0
  v_writelane_b32 v44, s12, 19
  v_writelane_b32 v45, s13, 19
  v_writelane_b32 v44, s28, 20
  v_writelane_b32 v45, s29, 20
  s_add_u32 s12, s28, 1605628
  s_addc_u32 s13, s29, 0
  v_writelane_b32 v44, s12, 21
  v_writelane_b32 v45, s13, 21
  v_writelane_b32 v44, s20, 22
  v_writelane_b32 v45, s21, 22
  s_add_u32 s12, s20, 401404
  s_addc_u32 s13, s21, 0
  v_writelane_b32 v44, s12, 23
  v_writelane_b32 v45, s13, 23
  v_writelane_b32 v44, s30, 24
  v_writelane_b32 v45, s31, 24
  s_add_u32 s12, s30, 1835004
  s_addc_u32 s13, s31, 0
  v_writelane_b32 v44, s12, 25
  v_writelane_b32 v45, s13, 25
  v_writelane_b32 v44, s32, 26
  v_writelane_b32 v45, s33, 26
  s_add_u32 s12, s32, 252
  s_addc_u32 s13, s33, 0
  v_writelane_b32 v44, s12, 27
  v_writelane_b32 v45, s13, 27
  global_load_dword v46, v[44:45], off sc1
L_notlbVKGUS:
  s_mov_b32 s72, s26
  s_mov_b32 s73, s27
  s_mov_b32 s74, 1605632
  s_mov_b32 s75, 0x20000
  s_mov_b32 s48, s28
  s_mov_b32 s49, s29
  s_mov_b32 s50, 1605632
  s_mov_b32 s51, 0x20000
  s_mov_b32 s52, s20
  s_mov_b32 s53, s21
  s_mov_b32 s54, 401408
  s_mov_b32 s55, 0x20000
  s_mov_b32 s44, s34
  s_mov_b32 s45, s35
  s_mov_b32 s46, 18874368
  s_mov_b32 s47, 0x20000
  s_mov_b32 s96, s32
  s_mov_b32 s97, s33
  s_mov_b32 s98, 256
  s_mov_b32 s99, 0x20000
  s_cmp_eq_u32 s9, 0
  s_cselect_b32 s76, s24, s26
  s_cselect_b32 s77, s25, s27
  s_mov_b32 s78, 1605632
  s_mov_b32 s79, 0x20000
  s_lshl_b32 s57, s10, 11
  s_lshl_b32 s12, s9, 10
  s_add_u32 s57, s57, s12
  s_lshl_b32 s68, s7, 12
  s_lshl_b32 s12, s62, 7
  s_add_u32 s68, s68, s12
  s_lshl_b32 s12, s8, 11
  s_add_u32 s68, s68, s12
  s_add_u32 s68, s68, 17825792
  s_lshl_b32 s69, s62, 12
  s_lshl_b32 s12, s7, 9
  s_add_u32 s69, s69, s12
  s_xor_b32 s12, s8, 1
  s_lshl_b32 s12, s12, 7
  s_add_u32 s69, s69, s12
  s_add_u32 s69, s69, 17891328
  s_mov_b32 s58, s69
  s_lshl_b32 s62, s5, 12
  s_add_u32 s62, s62, 17825792
  s_and_b32 s63, s6, 15
  s_add_u32 s63, s63, 16
  v_mov_b32 v6, s63
  v_cmp_gt_u32 vcc, 16, v0
  s_nop 1
  v_cndmask_b32 v6, v6, v0, vcc
  v_lshlrev_b32 v6, 7, v6
  s_lshl_b32 s13, s2, 2
  s_add_u32 s13, s13, s4
  s_lshl_b32 s13, s13, 10
  s_add_u32 s14, s13, 1048576
  buffer_load_dwordx4 v[24:27], v1, s[36:39], s13 offen
  buffer_load_dwordx4 v[24:27], v1, s[36:39], s14 offen
  buffer_load_dwordx4 v[24:27], v1, s[40:43], s13 offen
  buffer_load_dwordx4 v[24:27], v1, s[40:43], s14 offen
  buffer_load_dwordx4 v[24:27], v1, s[72:75], s13 offen
  buffer_load_dwordx4 v[24:27], v1, s[72:75], s14 offen
  s_barrier
  s_barrier
  s_setprio 0
  s_add_u32 m0, s56, 159744
  s_add_u32 s13, s65, 430080
  buffer_load_dwordx4 v2, s[36:39], s13 offen lds
  s_add_u32 m0, s56, 0
  s_add_u32 s13, s64, 516096
  buffer_load_dwordx4 v2, s[36:39], s13 offen lds
  s_add_u32 m0, s56, 4096
  s_add_u32 s13, s64, 602112
  buffer_load_dwordx4 v2, s[36:39], s13 offen lds
  s_add_u32 m0, s56, 8192
  s_add_u32 s13, s65, 516096
  buffer_load_dwordx4 v2, s[36:39], s13 offen lds
  s_add_u32 m0, s56, 12288
  s_add_u32 s13, s65, 602112
  buffer_load_dwordx4 v2, s[36:39], s13 offen lds
  s_waitcnt vmcnt(14)
  s_barrier
  s_add_u32 m0, s56, 16384
  s_add_u32 s13, s64, 688128
  buffer_load_dwordx4 v2, s[36:39], s13 offen lds
  s_add_u32 m0, s56, 20480
  s_add_u32 s13, s64, 774144
  buffer_load_dwordx4 v2, s[36:39], s13 offen lds
  s_add_u32 m0, s56, 24576
  s_add_u32 s13, s65, 688128
  buffer_load_dwordx4 v2, s[36:39], s13 offen lds
  s_add_u32 m0, s56, 28672
  s_add_u32 s13, s65, 774144
  buffer_load_dwordx4 v2, s[36:39], s13 offen lds
  s_add_u32 m0, s56, 32768
  s_add_u32 s13, s64, 860160
  buffer_load_dwordx4 v2, s[36:39], s13 offen lds
  s_add_u32 m0, s56, 36864
  s_add_u32 s13, s64, 946176
  buffer_load_dwordx4 v2, s[36:39], s13 offen lds
  s_add_u32 m0, s56, 40960
  s_add_u32 s13, s65, 860160
  buffer_load_dwordx4 v2, s[36:39], s13 offen lds
  s_add_u32 m0, s56, 45056
  s_add_u32 s13, s65, 946176
  buffer_load_dwordx4 v2, s[36:39], s13 offen lds
  s_waitcnt vmcnt(12)
  s_barrier
  s_add_u32 m0, s56, 49152
  s_add_u32 s13, s64, 1032192
  buffer_load_dwordx4 v2, s[36:39], s13 offen lds
  s_add_u32 m0, s56, 53248
  s_add_u32 s13, s64, 1118208
  buffer_load_dwordx4 v2, s[36:39], s13 offen lds
  s_add_u32 m0, s56, 57344
  s_add_u32 s13, s65, 1032192
  buffer_load_dwordx4 v2, s[36:39], s13 offen lds
  s_add_u32 m0, s56, 61440
  s_add_u32 s13, s65, 1118208
  buffer_load_dwordx4 v2, s[36:39], s13 offen lds
  s_add_u32 m0, s56, 65536
  s_add_u32 s13, s66, 0
  buffer_load_dwordx4 v3, s[40:43], s13 offen lds
  s_waitcnt vmcnt(13)
  s_barrier
  s_add_u32 m0, s56, 69632
  s_add_u32 s13, s66, 114688
  buffer_load_dwordx4 v3, s[40:43], s13 offen lds
  s_add_u32 m0, s56, 73728
  s_add_u32 s13, s66, 229376
  buffer_load_dwordx4 v3, s[40:43], s13 offen lds
  s_add_u32 m0, s56, 77824
  s_add_u32 s13, s66, 344064
  buffer_load_dwordx4 v3, s[40:43], s13 offen lds
  s_add_u32 m0, s56, 81920
  s_add_u32 s13, s66, 458752
  buffer_load_dwordx4 v3, s[40:43], s13 offen lds
  s_add_u32 m0, s56, 86016
  s_add_u32 s13, s66, 573440
  buffer_load_dwordx4 v3, s[40:43], s13 offen lds
  buffer_load_dwordx2 v[4:5], off, s[96:99], 0 sc1
  s_waitcnt vmcnt(15)
  s_barrier
  s_add_u32 m0, s56, 90112
  s_add_u32 s13, s66, 688128
  buffer_load_dwordx4 v3, s[40:43], s13 offen lds
  s_add_u32 m0, s56, 94208
  s_add_u32 s13, s66, 802816
  buffer_load_dwordx4 v3, s[40:43], s13 offen lds
  s_add_u32 m0, s56, 98304
  s_add_u32 s13, s66, 917504
  buffer_load_dwordx4 v3, s[40:43], s13 offen lds
  s_add_u32 m0, s56, 102400
  s_add_u32 s13, s66, 1032192
  buffer_load_dwordx4 v3, s[40:43], s13 offen lds
  s_add_u32 m0, s56, 106496
  s_add_u32 s13, s66, 1146880
  buffer_load_dwordx4 v3, s[40:43], s13 offen lds
  s_waitcnt vmcnt(16)
  s_barrier
  s_add_u32 m0, s56, 110592
  s_add_u32 s13, s66, 1261568
  buffer_load_dwordx4 v3, s[40:43], s13 offen lds
  s_add_u32 m0, s56, 114688
  s_add_u32 s13, s66, 1376256
  buffer_load_dwordx4 v3, s[40:43], s13 offen lds
  s_add_u32 m0, s56, 118784
  s_add_u32 s13, s66, 1490944
  buffer_load_dwordx4 v3, s[40:43], s13 offen lds
  s_add_u32 m0, s56, 131072
  s_add_u32 s13, s66, 0
  buffer_load_dwordx4 v3, s[72:75], s13 offen lds
  s_add_u32 m0, s56, 135168
  s_add_u32 s13, s66, 114688
  buffer_load_dwordx4 v3, s[72:75], s13 offen lds
  s_waitcnt vmcnt(17)
  s_barrier
  s_add_u32 m0, s56, 139264
  s_add_u32 s13, s66, 229376
  buffer_load_dwordx4 v3, s[72:75], s13 offen lds
  s_add_u32 m0, s56, 143360
  s_add_u32 s13, s66, 344064
  buffer_load_dwordx4 v3, s[72:75], s13 offen lds
  s_add_u32 m0, s56, 147456
  s_add_u32 s13, s66, 458752
  buffer_load_dwordx4 v3, s[72:75], s13 offen lds
  s_add_u32 m0, s56, 151552
  s_add_u32 s13, s66, 573440
  buffer_load_dwordx4 v3, s[72:75], s13 offen lds
  s_add_u32 m0, s56, 155648
  s_add_u32 s13, s66, 688128
  buffer_load_dwordx4 v3, s[72:75], s13 offen lds
  s_waitcnt vmcnt(18)
  s_barrier
  s_add_u32 m0, s56, 159744
  s_add_u32 s13, s66, 802816
  buffer_load_dwordx4 v3, s[72:75], s13 offen lds
  s_add_u32 m0, s56, 0
  s_add_u32 s13, s66, 917504
  buffer_load_dwordx4 v3, s[72:75], s13 offen lds
  s_add_u32 m0, s56, 4096
  s_add_u32 s13, s66, 1032192
  buffer_load_dwordx4 v3, s[72:75], s13 offen lds
  s_add_u32 m0, s56, 8192
  s_add_u32 s13, s66, 1146880
  buffer_load_dwordx4 v3, s[72:75], s13 offen lds
  s_add_u32 m0, s56, 12288
  s_add_u32 s13, s66, 1261568
  buffer_load_dwordx4 v3, s[72:75], s13 offen lds
  s_waitcnt vmcnt(18)
  s_barrier
  s_add_u32 m0, s56, 16384
  s_add_u32 s13, s66, 1376256
  buffer_load_dwordx4 v3, s[72:75], s13 offen lds
  s_add_u32 m0, s56, 20480
  s_add_u32 s13, s66, 1490944
  buffer_load_dwordx4 v3, s[72:75], s13 offen lds
  s_add_u32 m0, s57, 32768
  s_add_u32 s13, s67, 0
  buffer_load_dwordx4 v7, s[76:79], s13 offen lds
  s_add_u32 m0, s57, 36864
  s_add_u32 s13, s67, 114688
  buffer_load_dwordx4 v7, s[76:79], s13 offen lds
  s_add_u32 m0, s57, 40960
  s_add_u32 s13, s67, 229376
  buffer_load_dwordx4 v7, s[76:79], s13 offen lds
  s_mov_b32 s12, 4096
L_tqVKGUS:
  v_cmp_ne_u32 vcc, 0, v4
  s_sub_u32 s12, s12, 1
  s_cbranch_scc1 L_trVKGUS
  s_cmp_lg_u64 vcc, 0
  s_cbranch_scc1 L_trVKGUS
  buffer_load_dwordx2 v[4:5], off, s[96:99], 0 sc1
  s_waitcnt vmcnt(0)
  s_branch L_tqVKGUS
L_trVKGUS:
  s_waitcnt vmcnt(19)
  s_barrier
  s_add_u32 m0, s57, 45056
  s_add_u32 s13, s67, 344064
  buffer_load_dwordx4 v7, s[76:79], s13 offen lds
  s_add_u32 m0, s57, 49152
  s_add_u32 s13, s67, 458752
  buffer_load_dwordx4 v7, s[76:79], s13 offen lds
  s_add_u32 m0, s57, 53248
  s_add_u32 s13, s67, 573440
  buffer_load_dwordx4 v7, s[76:79], s13 offen lds
  s_add_u32 m0, s57, 57344
  s_add_u32 s13, s67, 688128
  buffer_load_dwordx4 v7, s[76:79], s13 offen lds
  s_add_u32 m0, s57, 61440
  s_add_u32 s13, s67, 802816
  buffer_load_dwordx4 v7, s[76:79], s13 offen lds
  s_waitcnt vmcnt(22)
  s_barrier
  s_add_u32 m0, s57, 65536
  s_add_u32 s13, s67, 917504
  buffer_load_dwordx4 v7, s[76:79], s13 offen lds
  s_add_u32 m0, s57, 69632
  s_add_u32 s13, s67, 1032192
  buffer_load_dwordx4 v7, s[76:79], s13 offen lds
  s_add_u32 m0, s57, 73728
  s_add_u32 s13, s67, 1146880
  buffer_load_dwordx4 v7, s[76:79], s13 offen lds
  s_add_u32 m0, s57, 77824
  s_add_u32 s13, s67, 1261568
  buffer_load_dwordx4 v7, s[76:79], s13 offen lds
  s_add_u32 m0, s57, 81920
  s_add_u32 s13, s67, 1376256
  buffer_load_dwordx4 v7, s[76:79], s13 offen lds
  s_waitcnt vmcnt(23)
  s_barrier
  s_add_u32 m0, s57, 86016
  s_add_u32 s13, s67, 1490944
  buffer_load_dwordx4 v7, s[76:79], s13 offen lds
  s_cmp_lg_u32 s4, 0
  s_cbranch_scc1 L_noinitVKGUS
  v_lshlrev_b32 v22, 2, v0
  v_add_u32 v22, 113664, v22
  v_mov_b32 v23, 0
  ds_write_b32 v22, v23
  v_mov_b32 v22, 113768
  s_waitcnt lgkmcnt(0)
  ds_write_b64 v22, v[4:5]
  s_waitcnt lgkmcnt(0)
L_noinitVKGUS:
  s_waitcnt vmcnt(20)
  s_barrier
  s_cmp_lg_u32 s4, 0
  s_cbranch_scc1 L_npVKGUS11
  s_mov_b64 exec, 1
  buffer_store_dwordx2 v[4:5], off, s[44:47], s68 sc1
  s_mov_b64 exec, -1
L_npVKGUS11:
  s_waitcnt vmcnt(16)
  s_barrier
  s_waitcnt vmcnt(14)
  s_barrier
  s_waitcnt vmcnt(10)
  s_barrier
  buffer_load_dwordx2 v[8:9], v6, s[44:47], s62 offen sc1
  s_waitcnt vmcnt(7)
  s_barrier
  s_branch L_ld_done
L_ld_b:
  s_add_u32 m0, s56, 114688
  s_add_u32 s13, s64, 0
  buffer_load_dwordx4 v2, s[36:39], s13 offen lds
  s_add_u32 m0, s56, 118784
  s_add_u32 s13, s64, 86016
  buffer_load_dwordx4 v2, s[36:39], s13 offen lds
  s_add_u32 m0, s56, 122880
  s_add_u32 s13, s66, 0
  buffer_load_dwordx4 v3, s[40:43], s13 offen lds
  s_add_u32 m0, s56, 126976
  s_add_u32 s13, s66, 114688
  buffer_load_dwordx4 v3, s[40:43], s13 offen lds
  s_add_u32 m0, s56, 131072
  s_add_u32 s13, s64, 172032
  buffer_load_dwordx4 v2, s[36:39], s13 offen lds
  s_add_u32 m0, s56, 135168
  s_add_u32 s13, s64, 258048
  buffer_load_dwordx4 v2, s[36:39], s13 offen lds
  s_add_u32 m0, s56, 139264
  s_add_u32 s13, s66, 229376
  buffer_load_dwordx4 v3, s[40:43], s13 offen lds
  s_add_u32 m0, s56, 143360
  s_add_u32 s13, s66, 344064
  buffer_load_dwordx4 v3, s[40:43], s13 offen lds
  s_add_u32 m0, s56, 147456
  s_add_u32 s13, s64, 344064
  buffer_load_dwordx4 v2, s[36:39], s13 offen lds
  s_add_u32 m0, s56, 151552
  s_add_u32 s13, s64, 430080
  buffer_load_dwordx4 v2, s[36:39], s13 offen lds
  s_add_u32 m0, s56, 155648
  s_add_u32 s13, s66, 458752
  buffer_load_dwordx4 v3, s[40:43], s13 offen lds
  s_cmp_lg_u32 s4, 0
  s_cbranch_scc1 L_notlbQGUgu
  v_min_u32 v44, 8, v0
  v_lshlrev_b32 v44, 21, v44
  v_mov_b32 v45, s35
  v_add_co_u32 v44, vcc, s34, v44
  s_nop 1
  v_addc_co_u32 v45, vcc, 0, v45, vcc
  v_writelane_b32 v44, s24, 16
  v_writelane_b32 v45, s25, 16
  s_add_u32 s12, s24, 1605628
  s_addc_u32 s13, s25, 0
  v_writelane_b32 v44, s12, 17
  v_writelane_b32 v45, s13, 17
  v_writelane_b32 v44, s26, 18
  v_writelane_b32 v45, s27, 18
  s_add_u32 s12, s26, 1605628
  s_addc_u32 s13, s27, 0
  v_writelane_b32 v44, s12, 19
  v_writelane_b32 v45, s13, 19
  v_writelane_b32 v44, s28, 20
  v_writelane_b32 v45, s29, 20
  s_add_u32 s12, s28, 1605628
  s_addc_u32 s13, s29, 0
  v_writelane_b32 v44, s12, 21
  v_writelane_b32 v45, s13, 21
  v_writelane_b32 v44, s20, 22
  v_writelane_b32 v45, s21, 22
  s_add_u32 s12, s20, 401404
  s_addc_u32 s13, s21, 0
  v_writelane_b32 v44, s12, 23
  v_writelane_b32 v45, s13, 23
  v_writelane_b32 v44, s30, 24
  v_writelane_b32 v45, s31, 24
  s_add_u32 s12, s30, 1835004
  s_addc_u32 s13, s31, 0
  v_writelane_b32 v44, s12, 25
  v_writelane_b32 v45, s13, 25
  v_writelane_b32 v44, s32, 26
  v_writelane_b32 v45, s33, 26
  s_add_u32 s12, s32, 252
  s_addc_u32 s13, s33, 0
  v_writelane_b32 v44, s12, 27
  v_writelane_b32 v45, s13, 27
  global_load_dword v46, v[44:45], off sc1
L_notlbQGUgu:
  s_mov_b32 s72, s26
  s_mov_b32 s73, s27
  s_mov_b32 s74, 1605632
  s_mov_b32 s75, 0x20000
  s_mov_b32 s48, s28
  s_mov_b32 s49, s29
  s_mov_b32 s50, 1605632
  s_mov_b32 s51, 0x20000
  s_mov_b32 s52, s20
  s_mov_b32 s53, s21
  s_mov_b32 s54, 401408
  s_mov_b32 s55, 0x20000
  s_mov_b32 s44, s34
  s_mov_b32 s45, s35
  s_mov_b32 s46, 18874368
  s_mov_b32 s47, 0x20000
  s_mov_b32 s96, s32
  s_mov_b32 s97, s33
  s_mov_b32 s98, 256
  s_mov_b32 s99, 0x20000
  s_cmp_eq_u32 s9, 0
  s_cselect_b32 s76, s24, s26
  s_cselect_b32 s77, s25, s27
  s_mov_b32 s78, 1605632
  s_mov_b32 s79, 0x20000
  s_lshl_b32 s57, s10, 11
  s_lshl_b32 s12, s9, 10
  s_add_u32 s57, s57, s12
  s_lshl_b32 s68, s7, 12
  s_lshl_b32 s12, s62, 7
  s_add_u32 s68, s68, s12
  s_lshl_b32 s12, s8, 11
  s_add_u32 s68, s68, s12
  s_add_u32 s68, s68, 17825792
  s_lshl_b32 s69, s62, 12
  s_lshl_b32 s12, s7, 9
  s_add_u32 s69, s69, s12
  s_xor_b32 s12, s8, 1
  s_lshl_b32 s12, s12, 7
  s_add_u32 s69, s69, s12
  s_add_u32 s69, s69, 17891328
  s_mov_b32 s58, s69
  s_lshl_b32 s62, s5, 12
  s_add_u32 s62, s62, 17825792
  s_and_b32 s63, s6, 15
  s_add_u32 s63, s63, 16
  v_mov_b32 v6, s63
  v_cmp_gt_u32 vcc, 16, v0
  s_nop 1
  v_cndmask_b32 v6, v6, v0, vcc
  v_lshlrev_b32 v6, 7, v6
  s_lshl_b32 s13, s2, 2
  s_add_u32 s13, s13, s4
  s_lshl_b32 s13, s13, 10
  s_add_u32 s14, s13, 1048576
  buffer_load_dwordx4 v[24:27], v1, s[36:39], s13 offen
  buffer_load_dwordx4 v[24:27], v1, s[36:39], s14 offen
  buffer_load_dwordx4 v[24:27], v1, s[40:43], s13 offen
  buffer_load_dwordx4 v[24:27], v1, s[40:43], s14 offen
  buffer_load_dwordx4 v[24:27], v1, s[72:75], s13 offen
  buffer_load_dwordx4 v[24:27], v1, s[72:75], s14 offen
  s_barrier
  s_barrier
  s_setprio 0
  s_add_u32 m0, s56, 159744
  s_add_u32 s13, s66, 573440
  buffer_load_dwordx4 v3, s[40:43], s13 offen lds
  s_add_u32 m0, s56, 0
  s_add_u32 s13, s64, 516096
  buffer_load_dwordx4 v2, s[36:39], s13 offen lds
  s_add_u32 m0, s56, 4096
  s_add_u32 s13, s64, 602112
  buffer_load_dwordx4 v2, s[36:39], s13 offen lds
  s_add_u32 m0, s56, 8192
  s_add_u32 s13, s66, 688128
  buffer_load_dwordx4 v3, s[40:43], s13 offen lds
  s_add_u32 m0, s56, 12288
  s_add_u32 s13, s66, 802816
  buffer_load_dwordx4 v3, s[40:43], s13 offen lds
  s_waitcnt vmcnt(14)
  s_barrier
  s_add_u32 m0, s56, 16384
  s_add_u32 s13, s64, 688128
  buffer_load_dwordx4 v2, s[36:39], s13 offen lds
  s_add_u32 m0, s56, 20480
  s_add_u32 s13, s64, 774144
  buffer_load_dwordx4 v2, s[36:39], s13 offen lds
  s_add_u32 m0, s56, 24576
  s_add_u32 s13, s66, 917504
  buffer_load_dwordx4 v3, s[40:43], s13 offen lds
  s_add_u32 m0, s56, 28672
  s_add_u32 s13, s66, 1032192
  buffer_load_dwordx4 v3, s[40:43], s13 offen lds
  s_add_u32 m0, s56, 32768
  s_add_u32 s13, s64, 860160
  buffer_load_dwordx4 v2, s[36:39], s13 offen lds
  s_add_u32 m0, s56, 36864
  s_add_u32 s13, s64, 946176
  buffer_load_dwordx4 v2, s[36:39], s13 offen lds
  s_add_u32 m0, s56, 40960
  s_add_u32 s13, s66, 1146880
  buffer_load_dwordx4 v3, s[40:43], s13 offen lds
  s_add_u32 m0, s56, 45056
  s_add_u32 s13, s66, 1261568
  buffer_load_dwordx4 v3, s[40:43], s13 offen lds
  s_waitcnt vmcnt(12)
  s_barrier
  s_add_u32 m0, s56, 49152
  s_add_u32 s13, s64, 1032192
  buffer_load_dwordx4 v2, s[36:39], s13 offen lds
  s_add_u32 m0, s56, 53248
  s_add_u32 s13, s64, 1118208
  buffer_load_dwordx4 v2, s[36:39], s13 offen lds
  s_add_u32 m0, s56, 57344
  s_add_u32 s13, s66, 1376256
  buffer_load_dwordx4 v3, s[40:43], s13 offen lds
  s_add_u32 m0, s56, 61440
  s_add_u32 s13, s66, 1490944
  buffer_load_dwordx4 v3, s[40:43], s13 offen lds
  s_add_u32 m0, s56, 65536
  s_add_u32 s13, s66, 0
  buffer_load_dwordx4 v3, s[72:75], s13 offen lds
  s_waitcnt vmcnt(13)
  s_barrier
  s_add_u32 m0, s56, 69632
  s_add_u32 s13, s66, 114688
  buffer_load_dwordx4 v3, s[72:75], s13 offen lds
  s_add_u32 m0, s56, 73728
  s_add_u32 s13, s66, 229376
  buffer_load_dwordx4 v3, s[72:75], s13 offen lds
  s_add_u32 m0, s56, 77824
  s_add_u32 s13, s66, 344064
  buffer_load_dwordx4 v3, s[72:75], s13 offen lds
  s_add_u32 m0, s56, 81920
  s_add_u32 s13, s66, 458752
  buffer_load_dwordx4 v3, s[72:75], s13 offen lds
  s_add_u32 m0, s56, 86016
  s_add_u32 s13, s66, 573440
  buffer_load_dwordx4 v3, s[72:75], s13 offen lds
  buffer_load_dwordx2 v[4:5], off, s[96:99], 0 sc1
  s_waitcnt vmcnt(15)
  s_barrier
  s_add_u32 m0, s56, 90112
  s_add_u32 s13, s66, 688128
  buffer_load_dwordx4 v3, s[72:75], s13 offen lds
  s_add_u32 m0, s56, 94208
  s_add_u32 s13, s66, 802816
  buffer_load_dwordx4 v3, s[72:75], s13 offen lds
  s_add_u32 m0, s56, 98304
  s_add_u32 s13, s66, 917504
  buffer_load_dwordx4 v3, s[72:75], s13 offen lds
  s_add_u32 m0, s56, 102400
  s_add_u32 s13, s66, 1032192
  buffer_load_dwordx4 v3, s[72:75], s13 offen lds
  s_add_u32 m0, s56, 106496
  s_add_u32 s13, s66, 1146880
  buffer_load_dwordx4 v3, s[72:75], s13 offen lds
  s_waitcnt vmcnt(16)
  s_barrier
  s_add_u32 m0, s56, 110592
  s_add_u32 s13, s66, 1261568
  buffer_load_dwordx4 v3, s[72:75], s13 offen lds
  s_add_u32 m0, s56, 114688
  s_add_u32 s13, s66, 1376256
  buffer_load_dwordx4 v3, s[72:75], s13 offen lds
  s_add_u32 m0, s56, 118784
  s_add_u32 s13, s66, 1490944
  buffer_load_dwordx4 v3, s[72:75], s13 offen lds
  s_add_u32 m0, s56, 131072
  s_add_u32 s13, s66, 128
  buffer_load_dwordx4 v3, s[40:43], s13 offen lds
  s_add_u32 m0, s56, 135168
  s_add_u32 s13, s66, 114816
  buffer_load_dwordx4 v3, s[40:43], s13 offen lds
  s_waitcnt vmcnt(17)
  s_barrier
  s_add_u32 m0, s56, 139264
  s_add_u32 s13, s66, 229504
  buffer_load_dwordx4 v3, s[40:43], s13 offen lds
  s_add_u32 m0, s56, 143360
  s_add_u32 s13, s66, 344192
  buffer_load_dwordx4 v3, s[40:43], s13 offen lds
  s_add_u32 m0, s56, 147456
  s_add_u32 s13, s66, 458880
  buffer_load_dwordx4 v3, s[40:43], s13 offen lds
  s_add_u32 m0, s56, 151552
  s_add_u32 s13, s66, 573568
  buffer_load_dwordx4 v3, s[40:43], s13 offen lds
  s_add_u32 m0, s56, 155648
  s_add_u32 s13, s66, 688256
  buffer_load_dwordx4 v3, s[40:43], s13 offen lds
  s_waitcnt vmcnt(18)
  s_barrier
  s_add_u32 m0, s56, 159744
  s_add_u32 s13, s66, 802944
  buffer_load_dwordx4 v3, s[40:43], s13 offen lds
  s_add_u32 m0, s56, 0
  s_add_u32 s13, s66, 917632
  buffer_load_dwordx4 v3, s[40:43], s13 offen lds
  s_add_u32 m0, s56, 4096
  s_add_u32 s13, s66, 1032320
  buffer_load_dwordx4 v3, s[40:43], s13 offen lds
  s_add_u32 m0, s56, 8192
  s_add_u32 s13, s66, 1147008
  buffer_load_dwordx4 v3, s[40:43], s13 offen lds
  s_add_u32 m0, s56, 12288
  s_add_u32 s13, s66, 1261696
  buffer_load_dwordx4 v3, s[40:43], s13 offen lds
  s_waitcnt vmcnt(18)
  s_barrier
  s_add_u32 m0, s56, 16384
  s_add_u32 s13, s66, 1376384
  buffer_load_dwordx4 v3, s[40:43], s13 offen lds
  s_add_u32 m0, s56, 20480
  s_add_u32 s13, s66, 1491072
  buffer_load_dwordx4 v3, s[40:43], s13 offen lds
  s_add_u32 m0, s56, 32768
  s_add_u32 s13, s66, 128
  buffer_load_dwordx4 v3, s[72:75], s13 offen lds
  s_add_u32 m0, s56, 36864
  s_add_u32 s13, s66, 114816
  buffer_load_dwordx4 v3, s[72:75], s13 offen lds
  s_add_u32 m0, s56, 40960
  s_add_u32 s13, s66, 229504
  buffer_load_dwordx4 v3, s[72:75], s13 offen lds
  s_mov_b32 s12, 4096
L_tqQGUgu:
  v_cmp_ne_u32 vcc, 0, v4
  s_sub_u32 s12, s12, 1
  s_cbranch_scc1 L_trQGUgu
  s_cmp_lg_u64 vcc, 0
  s_cbranch_scc1 L_trQGUgu
  buffer_load_dwordx2 v[4:5], off, s[96:99], 0 sc1
  s_waitcnt vmcnt(0)
  s_branch L_tqQGUgu
L_trQGUgu:
  s_waitcnt vmcnt(19)
  s_barrier
  s_add_u32 m0, s56, 45056
  s_add_u32 s13, s66, 344192
  buffer_load_dwordx4 v3, s[72:75], s13 offen lds
  s_add_u32 m0, s56, 49152
  s_add_u32 s13, s66, 458880
  buffer_load_dwordx4 v3, s[72:75], s13 offen lds
  s_add_u32 m0, s56, 53248
  s_add_u32 s13, s66, 573568
  buffer_load_dwordx4 v3, s[72:75], s13 offen lds
  s_add_u32 m0, s56, 57344
  s_add_u32 s13, s66, 688256
  buffer_load_dwordx4 v3, s[72:75], s13 offen lds
  s_add_u32 m0, s56, 61440
  s_add_u32 s13, s66, 802944
  buffer_load_dwordx4 v3, s[72:75], s13 offen lds
  s_waitcnt vmcnt(22)
  s_barrier
  s_add_u32 m0, s56, 65536
  s_add_u32 s13, s66, 917632
  buffer_load_dwordx4 v3, s[72:75], s13 offen lds
  s_add_u32 m0, s56, 69632
  s_add_u32 s13, s66, 1032320
  buffer_load_dwordx4 v3, s[72:75], s13 offen lds
  s_add_u32 m0, s56, 73728
  s_add_u32 s13, s66, 1147008
  buffer_load_dwordx4 v3, s[72:75], s13 offen lds
  s_add_u32 m0, s56, 77824
  s_add_u32 s13, s66, 1261696
  buffer_load_dwordx4 v3, s[72:75], s13 offen lds
  s_add_u32 m0, s56, 81920
  s_add_u32 s13, s66, 1376384
  buffer_load_dwordx4 v3, s[72:75], s13 offen lds
  s_waitcnt vmcnt(23)
  s_barrier
  s_cmp_lg_u32 s4, 0
  s_cbranch_scc1 L_npQGUgu10
  s_mov_b64 exec, 1
  buffer_store_dwordx2 v[4:5], off, s[44:47], s68 sc1
  s_mov_b64 exec, -1
L_npQGUgu10:
  s_add_u32 m0, s56, 86016
  s_add_u32 s13, s66, 1491072
  buffer_load_dwordx4 v3, s[72:75], s13 offen lds
  s_cmp_lg_u32 s4, 0
  s_cbranch_scc1 L_noinitQGUgu
  v_lshlrev_b32 v22, 2, v0
  v_add_u32 v22, 113664, v22
  v_mov_b32 v23, 0
  ds_write_b32 v22, v23
  v_mov_b32 v22, 113768
  s_waitcnt lgkmcnt(0)
  ds_write_b64 v22, v[4:5]
  s_waitcnt lgkmcnt(0)
L_noinitQGUgu:
  s_waitcnt vmcnt(20)
  s_barrier
  s_waitcnt vmcnt(16)
  s_barrier
  s_waitcnt vmcnt(14)
  s_barrier
  s_waitcnt vmcnt(10)
  s_barrier
  s_cmp_lg_u32 s4, 0
  s_cbranch_scc1 L_npQGUgu14
  s_mov_b64 exec, 1
  buffer_store_dwordx2 v[4:5], off, s[44:47], s69 sc1
  s_mov_b64 exec, -1
L_npQGUgu14:
  buffer_load_dwordx2 v[8:9], v6, s[44:47], s62 offen sc1
  s_waitcnt vmcnt(7)
  s_barrier
L_ld_done:
  s_add_u32 s65, s8, s4
  s_lshr_b32 s7, s6, 4
  s_lshl_b32 s8, s5, 1
  s_add_u32 s7, s7, s8
  s_and_b32 s8, s6, 15
  s_lshl_b32 s12, s7, 18
  s_add_u32 s12, s12, 2097152
  s_lshl_b32 s13, s4, 12
  v_add_u32 v2, s13, v1
  s_lshl_b32 s66, s7, 17
  s_lshl_b32 s3, s8, 13
  s_add_u32 s66, s66, s3
  s_lshl_b32 s3, s4, 11
  s_add_u32 s66, s66, s3
  s_add_u32 s66, s66, 0
  s_add_u32 s67, s3, 90112
  s_mov_b32 s68, 0
  s_mov_b32 s69, 0
  s_mov_b32 s70, 16
  s_mov_b32 s71, 4096
  s_mov_b32 s64, s13
  s_add_u32 s36, s34, s12
  s_addc_u32 s37, s35, 0
  s_mov_b32 s38, 262144
  s_mov_b32 s39, 0x20000
  s_mov_b32 s40, s34
  s_mov_b32 s41, s35
  s_mov_b32 s42, 18874368
  s_mov_b32 s43, 0x20000
L_pl:
  s_cmp_lg_u32 s68, 0
  s_cbranch_scc1 L_pl_ready
L_pl_eval:
  s_waitcnt vmcnt(0)
  v_cmp_eq_u64 s[60:61], v[8:9], v[4:5]
  s_sub_u32 s71, s71, 1
  s_cselect_b32 s68, 1, 0
  s_cmp_eq_u64 s[60:61], -1
  s_cselect_b32 s68, 1, s68
  s_cmp_lg_u32 s68, 0
  s_cbranch_scc1 L_pl_q
  buffer_load_dwordx2 v[8:9], v6, s[44:47], s62 offen sc1
  s_branch L_pl_bar
L_pl_q:
  s_mov_b32 m0, s67
  s_nop 0
  buffer_load_dwordx4 v1, s[40:43], s66 offen sc1 lds
  buffer_load_dwordx4 v1, s[40:43], s66 offen offset:1024 sc1 lds
L_pl_ready:
  s_add_u32 s3, s69, 15
  s_cmp_gt_u32 s3, s70
  s_cbranch_scc1 L_pl_bar
  s_cmp_ge_u32 s69, 4
  s_cbranch_scc1 L_pl_bar
  s_lshl_b32 s14, s69, 14
  s_mov_b32 m0, s64
  s_add_u32 s69, s69, 1
  buffer_load_dwordx4 v2, s[36:39], s14 offen sc1 lds
  buffer_load_dwordx4 v2, s[36:39], s14 offen offset:1024 sc1 lds
  buffer_load_dwordx4 v2, s[36:39], s14 offen offset:2048 sc1 lds
  buffer_load_dwordx4 v2, s[36:39], s14 offen offset:3072 sc1 lds
  s_add_u32 s64, s64, 16384
  s_branch L_pl_ready
L_pl_bar:
  s_cmp_ge_u32 s70, 19
  s_cbranch_scc1 L_pl_nobar
  s_barrier
  s_add_u32 s70, s70, 1
  s_branch L_pl
L_pl_nobar:
  s_cmp_ge_u32 s69, 4
  s_cbranch_scc1 L_pl_done
  s_sleep 4
  s_branch L_pl
L_pl_done:
  v_mov_b32 v8, 113664
  v_mov_b32 v9, 1
  s_mov_b64 exec, 1
  s_waitcnt vmcnt(8)
  ds_add_u32 v8, v9 offset:96
  s_waitcnt vmcnt(0)
  ds_add_u32 v8, v9 offset:4
  ds_add_u32 v8, v9 offset:132
  s_mov_b64 exec, -1
  s_mul_i32 s14, s8, 12288
  s_mul_i32 s3, s4, 3072
  s_add_u32 s14, s14, s3
  s_add_u32 s14, s14, 65536
  buffer_load_dwordx4 v[12:15], v1, s[36:39], s14 offen sc1
  buffer_load_dwordx4 v[12:15], v1, s[36:39], s14 offen offset:1024 sc1
  buffer_load_dwordx4 v[12:15], v1, s[36:39], s14 offen offset:2048 sc1
  s_lshl_b32 s3, s2, 2
  s_add_u32 s3, s3, s4
  s_lshl_b32 s3, s3, 9
  buffer_load_dwordx4 v[12:15], v1, s[52:55], s3 offen
  s_lshl_b32 s3, s3, 2
  buffer_load_dwordx4 v[12:15], v1, s[48:51], s3 offen
  buffer_load_dwordx4 v[12:15], v1, s[48:51], s3 offen offset:1024
  s_barrier
  s_cmp_lg_u32 s65, 0
  s_cbranch_scc1 L_np19
  s_mov_b64 exec, 1
  buffer_store_dwordx2 v[4:5], off, s[40:43], s58 sc1
  s_mov_b64 exec, -1
L_np19:
  s_cmp_ge_u32 s6, 28
  s_cbranch_scc1 L_s_end
  s_setprio 0
  s_and_b32 s9, s6, 3
  s_lshl_b32 s10, s5, 2
  s_add_u32 s9, s9, s10
  s_lshr_b32 s10, s6, 2
  s_lshr_b32 s11, s4, 1
  s_lshl_b32 s57, s9, 1
  s_add_u32 s57, s57, s11
  s_xor_b32 s58, s57, 1
  s_mul_i32 s3, s4, 24576
  s_add_u32 s3, s3, 6291456
  s_mul_i32 s60, s57, 114688
  s_add_u32 s60, s60, s3
  s_mul_i32 s61, s58, 114688
  s_add_u32 s61, s61, s3
  v_bfe_u32 v7, v0, 2, 3
  v_mul_u32_u24 v7, 896, v7
  v_lshrrev_b32 v3, 5, v0
  v_lshl_add_u32 v7, v3, 6, v7
  v_and_b32 v3, 3, v0
  v_lshl_add_u32 v7, v3, 4, v7
  s_lshl_b32 s14, s10, 7
  v_add_u32 v2, s14, v7
  v_lshrrev_b32 v7, 5, v0
  v_lshlrev_b32 v7, 8, v7
  v_bfe_u32 v3, v0, 2, 2
  v_lshl_add_u32 v7, v3, 6, v7
  v_bfe_u32 v3, v0, 4, 1
  v_lshl_add_u32 v7, v3, 5, v7
  v_and_b32 v3, 3, v0
  v_lshl_add_u32 v7, v3, 3, v7
  s_lshl_b32 s15, s4, 14
  s_add_u32 s15, s15, 98304
  s_and_b32 s3, s4, 1
  s_lshl_b32 s3, s3, 9
  s_add_u32 s3, s3, s15
  v_add_u32 v3, s3, v7
  v_xor_b32 v6, 512, v3
  s_mul_i32 s62, s4, 344064
  s_mul_i32 s63, s4, -10
  s_add_u32 s63, s63, 48
  s_lshl_b32 s64, s63, 11
  s_add_u32 s65, s64, s61
  s_add_u32 s64, s64, s60
  s_mul_i32 s63, s63, 28672
  s_add_u32 s63, s63, s62
  v_and_b32 v144, 7, v0
  v_lshlrev_b32 v144, 7, v144
  s_lshr_b32 s66, s9, 1
  s_lshl_b32 s66, s66, 12
  s_lshl_b32 s3, s4, 10
  s_add_u32 s66, s66, s3
  s_add_u32 s66, s66, 17891328
  s_mov_b32 s71, 4096
  s_mul_i32 s67, s4, 100352
  v_and_b32 v7, 31, v0
  s_lshl_b32 s14, s57, 5
  v_add_u32 v7, s14, v7
  v_mul_u32_u24 v7, 896, v7
  v_lshrrev_b32 v0, 5, v0
  v_lshl_add_u32 v7, v0, 3, v7
  s_and_b32 s14, s4, 1
  s_lshl_b32 s14, s14, 6
  s_lshl_b32 s3, s10, 7
  s_add_u32 s14, s14, s3
  v_add_u32 v0, s14, v7
  s_mov_b32 s44, s16
  s_mov_b32 s45, s17
  s_mov_b32 s46, 1835008
  s_mov_b32 s47, 0x20000
  buffer_load_dwordx2 v[160:161], v0, s[44:47], 0 offen offset:0
  buffer_load_dwordx2 v[162:163], v0, s[44:47], 0 offen offset:16
  buffer_load_dwordx2 v[164:165], v0, s[44:47], 0 offen offset:32
  buffer_load_dwordx2 v[166:167], v0, s[44:47], 0 offen offset:48
  s_add_u32 m0, s15, 0
  s_add_u32 s14, s62, 0
  buffer_load_dwordx4 v2, s[48:51], s14 offen lds
  s_add_u32 m0, s15, 1024
  s_add_u32 s14, s62, 7168
  buffer_load_dwordx4 v2, s[48:51], s14 offen lds
  s_add_u32 m0, s15, 2048
  s_add_u32 s14, s62, 14336
  buffer_load_dwordx4 v2, s[48:51], s14 offen lds
  s_add_u32 m0, s15, 3072
  s_add_u32 s14, s62, 21504
  buffer_load_dwordx4 v2, s[48:51], s14 offen lds
  s_mov_b32 s68, 17
  s_mov_b32 s69, 0
  s_mov_b32 s71, 4096
L_hp0:
  buffer_load_dwordx2 v[146:147], v144, s[40:43], s66 offen sc1
  s_sub_u32 s71, s71, 1
  s_waitcnt vmcnt(0)
  v_cmp_eq_u64 vcc, v[146:147], v[4:5]
  s_cmp_eq_u32 s71, 0
  s_cbranch_scc1 L_hp0_x
  s_and_b64 vcc, vcc, s[68:69]
  s_cmp_eq_u64 vcc, s[68:69]
  s_cbranch_scc1 L_hp0_x
  s_sleep 8
  s_branch L_hp0
L_hp0_x:
  buffer_load_dwordx4 v[88:91], v1, s[40:43], s60 offen offset:0 sc1
  buffer_load_dwordx4 v[92:95], v1, s[40:43], s61 offen offset:0 sc1
  s_add_u32 m0, s15, 4096
  s_add_u32 s14, s62, 28672
  buffer_load_dwordx4 v2, s[48:51], s14 offen lds
  s_add_u32 m0, s15, 5120
  s_add_u32 s14, s62, 35840
  buffer_load_dwordx4 v2, s[48:51], s14 offen lds
  buffer_load_dwordx4 v[96:99], v1, s[40:43], s60 offen offset:1024 sc1
  buffer_load_dwordx4 v[100:103], v1, s[40:43], s61 offen offset:1024 sc1
  s_add_u32 m0, s15, 6144
  s_add_u32 s14, s62, 43008
  buffer_load_dwordx4 v2, s[48:51], s14 offen lds
  s_add_u32 m0, s15, 7168
  s_add_u32 s14, s62, 50176
  buffer_load_dwordx4 v2, s[48:51], s14 offen lds
  buffer_load_dwordx4 v[104:107], v1, s[40:43], s60 offen offset:2048 sc1
  buffer_load_dwordx4 v[108:111], v1, s[40:43], s61 offen offset:2048 sc1
  s_add_u32 m0, s15, 8192
  s_add_u32 s14, s62, 172032
  buffer_load_dwordx4 v2, s[48:51], s14 offen lds
  s_add_u32 m0, s15, 9216
  s_add_u32 s14, s62, 179200
  buffer_load_dwordx4 v2, s[48:51], s14 offen lds
  buffer_load_dwordx4 v[112:115], v1, s[40:43], s60 offen offset:3072 sc1
  buffer_load_dwordx4 v[116:119], v1, s[40:43], s61 offen offset:3072 sc1
  s_add_u32 m0, s15, 10240
  s_add_u32 s14, s62, 186368
  buffer_load_dwordx4 v2, s[48:51], s14 offen lds
  s_add_u32 m0, s15, 11264
  s_add_u32 s14, s62, 193536
  buffer_load_dwordx4 v2, s[48:51], s14 offen lds
  s_add_u32 s14, s60, 12288
  buffer_load_dwordx4 v[120:123], v1, s[40:43], s14 offen offset:0 sc1
  s_add_u32 s14, s61, 12288
  buffer_load_dwordx4 v[124:127], v1, s[40:43], s14 offen offset:0 sc1
  s_add_u32 m0, s15, 12288
  s_add_u32 s14, s62, 200704
  buffer_load_dwordx4 v2, s[48:51], s14 offen lds
  s_add_u32 m0, s15, 13312
  s_add_u32 s14, s62, 207872
  buffer_load_dwordx4 v2, s[48:51], s14 offen lds
  s_add_u32 s14, s60, 12288
  buffer_load_dwordx4 v[128:131], v1, s[40:43], s14 offen offset:1024 sc1
  s_add_u32 s14, s61, 12288
  buffer_load_dwordx4 v[132:135], v1, s[40:43], s14 offen offset:1024 sc1
  s_add_u32 s14, s60, 12288
  buffer_load_dwordx4 v[136:139], v1, s[40:43], s14 offen offset:2048 sc1
  s_add_u32 s14, s61, 12288
  buffer_load_dwordx4 v[140:143], v1, s[40:43], s14 offen offset:2048 sc1
  s_setprio 0
  ds_read_b64_tr_b16 v[72:73], v3 offset:0
  ds_read_b64_tr_b16 v[74:75], v3 offset:1024
  ds_read_b64_tr_b16 v[76:77], v6 offset:0
  ds_read_b64_tr_b16 v[78:79], v6 offset:1024
  ds_read_b64_tr_b16 v[80:81], v3 offset:2048
  ds_read_b64_tr_b16 v[82:83], v3 offset:3072
  ds_read_b64_tr_b16 v[84:85], v6 offset:2048
  ds_read_b64_tr_b16 v[86:87], v6 offset:3072
  s_waitcnt vmcnt(22)
  s_waitcnt lgkmcnt(4)
  v_mfma_f32_32x32x16_bf16 v[8:23], v[72:75], v[88:91], 0
  v_mfma_f32_32x32x16_bf16 v[24:39], v[76:79], v[88:91], 0
  v_mfma_f32_32x32x16_bf16 v[40:55], v[72:75], v[92:95], 0
  v_mfma_f32_32x32x16_bf16 v[56:71], v[76:79], v[92:95], 0
  s_add_u32 s14, s60, 12288
  buffer_load_dwordx4 v[88:91], v1, s[40:43], s14 offen offset:3072 sc1
  s_add_u32 s14, s61, 12288
  buffer_load_dwordx4 v[92:95], v1, s[40:43], s14 offen offset:3072 sc1
  s_add_u32 m0, s15, 0
  s_add_u32 s14, s62, 215040
  buffer_load_dwordx4 v2, s[48:51], s14 offen lds
  s_add_u32 m0, s15, 1024
  s_add_u32 s14, s62, 222208
  buffer_load_dwordx4 v2, s[48:51], s14 offen lds
  s_waitcnt vmcnt(24)
  ds_read_b64_tr_b16 v[72:73], v3 offset:4096
  ds_read_b64_tr_b16 v[74:75], v3 offset:5120
  ds_read_b64_tr_b16 v[76:77], v6 offset:4096
  ds_read_b64_tr_b16 v[78:79], v6 offset:5120
  s_waitcnt vmcnt(22)
  s_waitcnt lgkmcnt(4)
  v_mfma_f32_32x32x16_bf16 v[8:23], v[80:83], v[96:99], v[8:23]
  v_mfma_f32_32x32x16_bf16 v[24:39], v[84:87], v[96:99], v[24:39]
  v_mfma_f32_32x32x16_bf16 v[40:55], v[80:83], v[100:103], v[40:55]
  v_mfma_f32_32x32x16_bf16 v[56:71], v[84:87], v[100:103], v[56:71]
  s_add_u32 m0, s15, 2048
  s_add_u32 s14, s62, 114688
  buffer_load_dwordx4 v2, s[48:51], s14 offen lds
  s_add_u32 m0, s15, 3072
  s_add_u32 s14, s62, 121856
  buffer_load_dwordx4 v2, s[48:51], s14 offen lds
  s_waitcnt vmcnt(22)
  ds_read_b64_tr_b16 v[80:81], v3 offset:6144
  ds_read_b64_tr_b16 v[82:83], v3 offset:7168
  ds_read_b64_tr_b16 v[84:85], v6 offset:6144
  ds_read_b64_tr_b16 v[86:87], v6 offset:7168
  s_waitcnt vmcnt(20)
  s_waitcnt lgkmcnt(4)
  v_mfma_f32_32x32x16_bf16 v[8:23], v[72:75], v[104:107], v[8:23]
  v_mfma_f32_32x32x16_bf16 v[24:39], v[76:79], v[104:107], v[24:39]
  v_mfma_f32_32x32x16_bf16 v[40:55], v[72:75], v[108:111], v[40:55]
  v_mfma_f32_32x32x16_bf16 v[56:71], v[76:79], v[108:111], v[56:71]
  s_add_u32 m0, s15, 4096
  s_add_u32 s14, s62, 129024
  buffer_load_dwordx4 v2, s[48:51], s14 offen lds
  s_add_u32 m0, s15, 5120
  s_add_u32 s14, s62, 136192
  buffer_load_dwordx4 v2, s[48:51], s14 offen lds
  s_waitcnt vmcnt(20)
  ds_read_b64_tr_b16 v[72:73], v3 offset:8192
  ds_read_b64_tr_b16 v[74:75], v3 offset:9216
  ds_read_b64_tr_b16 v[76:77], v6 offset:8192
  ds_read_b64_tr_b16 v[78:79], v6 offset:9216
  s_waitcnt vmcnt(18)
  s_waitcnt lgkmcnt(4)
  v_mfma_f32_32x32x16_bf16 v[8:23], v[80:83], v[112:115], v[8:23]
  v_mfma_f32_32x32x16_bf16 v[24:39], v[84:87], v[112:115], v[24:39]
  v_mfma_f32_32x32x16_bf16 v[40:55], v[80:83], v[116:119], v[40:55]
  v_mfma_f32_32x32x16_bf16 v[56:71], v[84:87], v[116:119], v[56:71]
  s_add_u32 m0, s15, 6144
  s_add_u32 s14, s62, 143360
  buffer_load_dwordx4 v2, s[48:51], s14 offen lds
  s_add_u32 m0, s15, 7168
  s_add_u32 s14, s62, 150528
  buffer_load_dwordx4 v2, s[48:51], s14 offen lds
  s_waitcnt vmcnt(18)
  ds_read_b64_tr_b16 v[80:81], v3 offset:10240
  ds_read_b64_tr_b16 v[82:83], v3 offset:11264
  ds_read_b64_tr_b16 v[84:85], v6 offset:10240
  ds_read_b64_tr_b16 v[86:87], v6 offset:11264
  s_waitcnt vmcnt(16)
  s_waitcnt lgkmcnt(4)
  v_mfma_f32_32x32x16_bf16 v[8:23], v[72:75], v[120:123], v[8:23]
  v_mfma_f32_32x32x16_bf16 v[24:39], v[76:79], v[120:123], v[24:39]
  v_mfma_f32_32x32x16_bf16 v[40:55], v[72:75], v[124:127], v[40:55]
  v_mfma_f32_32x32x16_bf16 v[56:71], v[76:79], v[124:127], v[56:71]
  s_mov_b32 s68, 34
  s_mov_b32 s69, 0
  s_mov_b32 s71, 4096
L_hp1:
  buffer_load_dwordx2 v[146:147], v144, s[40:43], s66 offen sc1
  s_sub_u32 s71, s71, 1
  s_waitcnt vmcnt(0)
  v_cmp_eq_u64 vcc, v[146:147], v[4:5]
  s_cmp_eq_u32 s71, 0
  s_cbranch_scc1 L_hp1_x
  s_and_b64 vcc, vcc, s[68:69]
  s_cmp_eq_u64 vcc, s[68:69]
  s_cbranch_scc1 L_hp1_x
  s_sleep 8
  s_branch L_hp1
L_hp1_x:
  s_add_u32 s14, s60, 8192
  buffer_load_dwordx4 v[96:99], v1, s[40:43], s14 offen offset:0 sc1
  s_add_u32 s14, s61, 8192
  buffer_load_dwordx4 v[100:103], v1, s[40:43], s14 offen offset:0 sc1
  s_add_u32 s14, s60, 8192
  buffer_load_dwordx4 v[104:107], v1, s[40:43], s14 offen offset:1024 sc1
  s_add_u32 s14, s61, 8192
  buffer_load_dwordx4 v[108:111], v1, s[40:43], s14 offen offset:1024 sc1
  s_add_u32 s14, s60, 8192
  buffer_load_dwordx4 v[112:115], v1, s[40:43], s14 offen offset:2048 sc1
  s_add_u32 s14, s61, 8192
  buffer_load_dwordx4 v[116:119], v1, s[40:43], s14 offen offset:2048 sc1
  s_add_u32 s14, s60, 8192
  buffer_load_dwordx4 v[120:123], v1, s[40:43], s14 offen offset:3072 sc1
  s_add_u32 s14, s61, 8192
  buffer_load_dwordx4 v[124:127], v1, s[40:43], s14 offen offset:3072 sc1
  s_add_u32 m0, s15, 8192
  s_add_u32 s14, s62, 157696
  buffer_load_dwordx4 v2, s[48:51], s14 offen lds
  s_add_u32 m0, s15, 9216
  s_add_u32 s14, s62, 164864
  buffer_load_dwordx4 v2, s[48:51], s14 offen lds
  ds_read_b64_tr_b16 v[72:73], v3 offset:12288
  ds_read_b64_tr_b16 v[74:75], v3 offset:13312
  ds_read_b64_tr_b16 v[76:77], v6 offset:12288
  ds_read_b64_tr_b16 v[78:79], v6 offset:13312
  s_waitcnt lgkmcnt(4)
  v_mfma_f32_32x32x16_bf16 v[8:23], v[80:83], v[128:131], v[8:23]
  v_mfma_f32_32x32x16_bf16 v[24:39], v[84:87], v[128:131], v[24:39]
  v_mfma_f32_32x32x16_bf16 v[40:55], v[80:83], v[132:135], v[40:55]
  v_mfma_f32_32x32x16_bf16 v[56:71], v[84:87], v[132:135], v[56:71]
  s_add_u32 s14, s60, 20480
  buffer_load_dwordx4 v[128:131], v1, s[40:43], s14 offen offset:0 sc1
  s_add_u32 s14, s61, 20480
  buffer_load_dwordx4 v[132:135], v1, s[40:43], s14 offen offset:0 sc1
  s_add_u32 m0, s15, 10240
  s_add_u32 s14, s62, 286720
  buffer_load_dwordx4 v2, s[48:51], s14 offen lds
  s_add_u32 m0, s15, 11264
  s_add_u32 s14, s62, 293888
  buffer_load_dwordx4 v2, s[48:51], s14 offen lds
  ds_read_b64_tr_b16 v[80:81], v3 offset:0
  ds_read_b64_tr_b16 v[82:83], v3 offset:1024
  ds_read_b64_tr_b16 v[84:85], v6 offset:0
  ds_read_b64_tr_b16 v[86:87], v6 offset:1024
  s_waitcnt lgkmcnt(4)
  v_mfma_f32_32x32x16_bf16 v[8:23], v[72:75], v[136:139], v[8:23]
  v_mfma_f32_32x32x16_bf16 v[24:39], v[76:79], v[136:139], v[24:39]
  v_mfma_f32_32x32x16_bf16 v[40:55], v[72:75], v[140:143], v[40:55]
  v_mfma_f32_32x32x16_bf16 v[56:71], v[76:79], v[140:143], v[56:71]
  s_add_u32 s14, s60, 20480
  buffer_load_dwordx4 v[136:139], v1, s[40:43], s14 offen offset:1024 sc1
  s_add_u32 s14, s61, 20480
  buffer_load_dwordx4 v[140:143], v1, s[40:43], s14 offen offset:1024 sc1
  s_add_u32 m0, s15, 12288
  s_add_u32 s14, s62, 301056
  buffer_load_dwordx4 v2, s[48:51], s14 offen lds
  s_add_u32 m0, s15, 13312
  s_add_u32 s14, s62, 308224
  buffer_load_dwordx4 v2, s[48:51], s14 offen lds
  ds_read_b64_tr_b16 v[72:73], v3 offset:2048
  ds_read_b64_tr_b16 v[74:75], v3 offset:3072
  ds_read_b64_tr_b16 v[76:77], v6 offset:2048
  ds_read_b64_tr_b16 v[78:79], v6 offset:3072
  s_waitcnt lgkmcnt(4)
  v_mfma_f32_32x32x16_bf16 v[8:23], v[80:83], v[88:91], v[8:23]
  v_mfma_f32_32x32x16_bf16 v[24:39], v[84:87], v[88:91], v[24:39]
  v_mfma_f32_32x32x16_bf16 v[40:55], v[80:83], v[92:95], v[40:55]
  v_mfma_f32_32x32x16_bf16 v[56:71], v[84:87], v[92:95], v[56:71]
  s_add_u32 s14, s60, 20480
  buffer_load_dwordx4 v[88:91], v1, s[40:43], s14 offen offset:2048 sc1
  s_add_u32 s14, s61, 20480
  buffer_load_dwordx4 v[92:95], v1, s[40:43], s14 offen offset:2048 sc1
  s_add_u32 m0, s15, 0
  s_add_u32 s14, s62, 315392
  buffer_load_dwordx4 v2, s[48:51], s14 offen lds
  s_add_u32 m0, s15, 1024
  s_add_u32 s14, s62, 322560
  buffer_load_dwordx4 v2, s[48:51], s14 offen lds
  ds_read_b64_tr_b16 v[80:81], v3 offset:4096
  ds_read_b64_tr_b16 v[82:83], v3 offset:5120
  ds_read_b64_tr_b16 v[84:85], v6 offset:4096
  ds_read_b64_tr_b16 v[86:87], v6 offset:5120
  s_waitcnt vmcnt(20)
  s_waitcnt lgkmcnt(4)
  v_mfma_f32_32x32x16_bf16 v[8:23], v[72:75], v[96:99], v[8:23]
  v_mfma_f32_32x32x16_bf16 v[24:39], v[76:79], v[96:99], v[24:39]
  v_mfma_f32_32x32x16_bf16 v[40:55], v[72:75], v[100:103], v[40:55]
  v_mfma_f32_32x32x16_bf16 v[56:71], v[76:79], v[100:103], v[56:71]
  s_add_u32 s14, s60, 20480
  buffer_load_dwordx4 v[96:99], v1, s[40:43], s14 offen offset:3072 sc1
  s_add_u32 s14, s61, 20480
  buffer_load_dwordx4 v[100:103], v1, s[40:43], s14 offen offset:3072 sc1
  s_add_u32 m0, s15, 2048
  s_add_u32 s14, s62, 329728
  buffer_load_dwordx4 v2, s[48:51], s14 offen lds
  s_add_u32 m0, s15, 3072
  s_add_u32 s14, s62, 336896
  buffer_load_dwordx4 v2, s[48:51], s14 offen lds
  ds_read_b64_tr_b16 v[72:73], v3 offset:6144
  ds_read_b64_tr_b16 v[74:75], v3 offset:7168
  ds_read_b64_tr_b16 v[76:77], v6 offset:6144
  ds_read_b64_tr_b16 v[78:79], v6 offset:7168
  s_waitcnt vmcnt(22)
  s_waitcnt lgkmcnt(4)
  v_mfma_f32_32x32x16_bf16 v[8:23], v[80:83], v[104:107], v[8:23]
  v_mfma_f32_32x32x16_bf16 v[24:39], v[84:87], v[104:107], v[24:39]
  v_mfma_f32_32x32x16_bf16 v[40:55], v[80:83], v[108:111], v[40:55]
  v_mfma_f32_32x32x16_bf16 v[56:71], v[84:87], v[108:111], v[56:71]
  s_add_u32 m0, s15, 4096
  s_add_u32 s14, s62, 57344
  buffer_load_dwordx4 v2, s[48:51], s14 offen lds
  s_add_u32 m0, s15, 5120
  s_add_u32 s14, s62, 64512
  buffer_load_dwordx4 v2, s[48:51], s14 offen lds
  s_waitcnt vmcnt(18)
  ds_read_b64_tr_b16 v[80:81], v3 offset:8192
  ds_read_b64_tr_b16 v[82:83], v3 offset:9216
  ds_read_b64_tr_b16 v[84:85], v6 offset:8192
  ds_read_b64_tr_b16 v[86:87], v6 offset:9216
  s_waitcnt lgkmcnt(4)
  v_mfma_f32_32x32x16_bf16 v[8:23], v[72:75], v[112:115], v[8:23]
  v_mfma_f32_32x32x16_bf16 v[24:39], v[76:79], v[112:115], v[24:39]
  v_mfma_f32_32x32x16_bf16 v[40:55], v[72:75], v[116:119], v[40:55]
  v_mfma_f32_32x32x16_bf16 v[56:71], v[76:79], v[116:119], v[56:71]
  s_add_u32 m0, s15, 6144
  s_add_u32 s14, s62, 71680
  buffer_load_dwordx4 v2, s[48:51], s14 offen lds
  s_add_u32 m0, s15, 7168
  s_add_u32 s14, s62, 78848
  buffer_load_dwordx4 v2, s[48:51], s14 offen lds
  s_waitcnt vmcnt(16)
  ds_read_b64_tr_b16 v[72:73], v3 offset:10240
  ds_read_b64_tr_b16 v[74:75], v3 offset:11264
  ds_read_b64_tr_b16 v[76:77], v6 offset:10240
  ds_read_b64_tr_b16 v[78:79], v6 offset:11264
  s_waitcnt lgkmcnt(4)
  v_mfma_f32_32x32x16_bf16 v[8:23], v[80:83], v[120:123], v[8:23]
  v_mfma_f32_32x32x16_bf16 v[24:39], v[84:87], v[120:123], v[24:39]
  v_mfma_f32_32x32x16_bf16 v[40:55], v[80:83], v[124:127], v[40:55]
  v_mfma_f32_32x32x16_bf16 v[56:71], v[84:87], v[124:127], v[56:71]
  s_add_u32 m0, s15, 8192
  s_add_u32 s14, s62, 86016
  buffer_load_dwordx4 v2, s[48:51], s14 offen lds
  s_add_u32 m0, s15, 9216
  s_add_u32 s14, s62, 93184
  buffer_load_dwordx4 v2, s[48:51], s14 offen lds
  s_waitcnt vmcnt(14)
  ds_read_b64_tr_b16 v[80:81], v3 offset:12288
  ds_read_b64_tr_b16 v[82:83], v3 offset:13312
  ds_read_b64_tr_b16 v[84:85], v6 offset:12288
  ds_read_b64_tr_b16 v[86:87], v6 offset:13312
  s_waitcnt lgkmcnt(4)
  v_mfma_f32_32x32x16_bf16 v[8:23], v[72:75], v[128:131], v[8:23]
  v_mfma_f32_32x32x16_bf16 v[24:39], v[76:79], v[128:131], v[24:39]
  v_mfma_f32_32x32x16_bf16 v[40:55], v[72:75], v[132:135], v[40:55]
  v_mfma_f32_32x32x16_bf16 v[56:71], v[76:79], v[132:135], v[56:71]
  s_mov_b32 s68, 204
  s_mov_b32 s69, 0
  s_mov_b32 s71, 4096
L_hp2:
  buffer_load_dwordx2 v[146:147], v144, s[40:43], s66 offen sc1
  s_sub_u32 s71, s71, 1
  s_waitcnt vmcnt(0)
  v_cmp_eq_u64 vcc, v[146:147], v[4:5]
  s_cmp_eq_u32 s71, 0
  s_cbranch_scc1 L_hp2_x
  s_and_b64 vcc, vcc, s[68:69]
  s_cmp_eq_u64 vcc, s[68:69]
  s_cbranch_scc1 L_hp2_x
  s_sleep 8
  s_branch L_hp2
L_hp2_x:
  s_add_u32 s14, s60, 4096
  buffer_load_dwordx4 v[104:107], v1, s[40:43], s14 offen offset:0 sc1
  s_add_u32 s14, s61, 4096
  buffer_load_dwordx4 v[108:111], v1, s[40:43], s14 offen offset:0 sc1
  s_add_u32 s14, s60, 4096
  buffer_load_dwordx4 v[112:115], v1, s[40:43], s14 offen offset:1024 sc1
  s_add_u32 s14, s61, 4096
  buffer_load_dwordx4 v[116:119], v1, s[40:43], s14 offen offset:1024 sc1
  s_add_u32 s14, s60, 4096
  buffer_load_dwordx4 v[120:123], v1, s[40:43], s14 offen offset:2048 sc1
  s_add_u32 s14, s61, 4096
  buffer_load_dwordx4 v[124:127], v1, s[40:43], s14 offen offset:2048 sc1
  s_add_u32 s14, s60, 4096
  buffer_load_dwordx4 v[128:131], v1, s[40:43], s14 offen offset:3072 sc1
  s_add_u32 s14, s61, 4096
  buffer_load_dwordx4 v[132:135], v1, s[40:43], s14 offen offset:3072 sc1
  s_add_u32 m0, s15, 10240
  s_add_u32 s14, s62, 100352
  buffer_load_dwordx4 v2, s[48:51], s14 offen lds
  s_add_u32 m0, s15, 11264
  s_add_u32 s14, s62, 107520
  buffer_load_dwordx4 v2, s[48:51], s14 offen lds
  ds_read_b64_tr_b16 v[72:73], v3 offset:0
  ds_read_b64_tr_b16 v[74:75], v3 offset:1024
  ds_read_b64_tr_b16 v[76:77], v6 offset:0
  ds_read_b64_tr_b16 v[78:79], v6 offset:1024
  s_waitcnt lgkmcnt(4)
  v_mfma_f32_32x32x16_bf16 v[8:23], v[80:83], v[136:139], v[8:23]
  v_mfma_f32_32x32x16_bf16 v[24:39], v[84:87], v[136:139], v[24:39]
  v_mfma_f32_32x32x16_bf16 v[40:55], v[80:83], v[140:143], v[40:55]
  v_mfma_f32_32x32x16_bf16 v[56:71], v[84:87], v[140:143], v[56:71]
  s_add_u32 s14, s60, 16384
  buffer_load_dwordx4 v[136:139], v1, s[40:43], s14 offen offset:0 sc1
  s_add_u32 s14, s61, 16384
  buffer_load_dwordx4 v[140:143], v1, s[40:43], s14 offen offset:0 sc1
  s_add_u32 m0, s15, 12288
  s_add_u32 s14, s62, 229376
  buffer_load_dwordx4 v2, s[48:51], s14 offen lds
  s_add_u32 m0, s15, 13312
  s_add_u32 s14, s62, 236544
  buffer_load_dwordx4 v2, s[48:51], s14 offen lds
  ds_read_b64_tr_b16 v[80:81], v3 offset:2048
  ds_read_b64_tr_b16 v[82:83], v3 offset:3072
  ds_read_b64_tr_b16 v[84:85], v6 offset:2048
  ds_read_b64_tr_b16 v[86:87], v6 offset:3072
  s_waitcnt lgkmcnt(4)
  v_mfma_f32_32x32x16_bf16 v[8:23], v[72:75], v[88:91], v[8:23]
  v_mfma_f32_32x32x16_bf16 v[24:39], v[76:79], v[88:91], v[24:39]
  v_mfma_f32_32x32x16_bf16 v[40:55], v[72:75], v[92:95], v[40:55]
  v_mfma_f32_32x32x16_bf16 v[56:71], v[76:79], v[92:95], v[56:71]
  s_add_u32 s14, s60, 16384
  buffer_load_dwordx4 v[88:91], v1, s[40:43], s14 offen offset:1024 sc1
  s_add_u32 s14, s61, 16384
  buffer_load_dwordx4 v[92:95], v1, s[40:43], s14 offen offset:1024 sc1
  s_add_u32 m0, s15, 0
  s_add_u32 s14, s62, 243712
  buffer_load_dwordx4 v2, s[48:51], s14 offen lds
  s_add_u32 m0, s15, 1024
  s_add_u32 s14, s62, 250880
  buffer_load_dwordx4 v2, s[48:51], s14 offen lds
  ds_read_b64_tr_b16 v[72:73], v3 offset:4096
  ds_read_b64_tr_b16 v[74:75], v3 offset:5120
  ds_read_b64_tr_b16 v[76:77], v6 offset:4096
  ds_read_b64_tr_b16 v[78:79], v6 offset:5120
  s_waitcnt lgkmcnt(4)
  v_mfma_f32_32x32x16_bf16 v[8:23], v[80:83], v[96:99], v[8:23]
  v_mfma_f32_32x32x16_bf16 v[24:39], v[84:87], v[96:99], v[24:39]
  v_mfma_f32_32x32x16_bf16 v[40:55], v[80:83], v[100:103], v[40:55]
  v_mfma_f32_32x32x16_bf16 v[56:71], v[84:87], v[100:103], v[56:71]
  s_add_u32 s14, s60, 16384
  buffer_load_dwordx4 v[96:99], v1, s[40:43], s14 offen offset:2048 sc1
  s_add_u32 s14, s61, 16384
  buffer_load_dwordx4 v[100:103], v1, s[40:43], s14 offen offset:2048 sc1
  s_add_u32 m0, s15, 2048
  s_add_u32 s14, s62, 258048
  buffer_load_dwordx4 v2, s[48:51], s14 offen lds
  s_add_u32 m0, s15, 3072
  s_add_u32 s14, s62, 265216
  buffer_load_dwordx4 v2, s[48:51], s14 offen lds
  ds_read_b64_tr_b16 v[80:81], v3 offset:6144
  ds_read_b64_tr_b16 v[82:83], v3 offset:7168
  ds_read_b64_tr_b16 v[84:85], v6 offset:6144
  ds_read_b64_tr_b16 v[86:87], v6 offset:7168
  s_waitcnt vmcnt(20)
  s_waitcnt lgkmcnt(4)
  v_mfma_f32_32x32x16_bf16 v[8:23], v[72:75], v[104:107], v[8:23]
  v_mfma_f32_32x32x16_bf16 v[24:39], v[76:79], v[104:107], v[24:39]
  v_mfma_f32_32x32x16_bf16 v[40:55], v[72:75], v[108:111], v[40:55]
  v_mfma_f32_32x32x16_bf16 v[56:71], v[76:79], v[108:111], v[56:71]
  s_add_u32 s14, s60, 16384
  buffer_load_dwordx4 v[104:107], v1, s[40:43], s14 offen offset:3072 sc1
  s_add_u32 s14, s61, 16384
  buffer_load_dwordx4 v[108:111], v1, s[40:43], s14 offen offset:3072 sc1
  s_add_u32 m0, s15, 4096
  s_add_u32 s14, s62, 272384
  buffer_load_dwordx4 v2, s[48:51], s14 offen lds
  s_add_u32 m0, s15, 5120
  s_add_u32 s14, s62, 279552
  buffer_load_dwordx4 v2, s[48:51], s14 offen lds
  ds_read_b64_tr_b16 v[72:73], v3 offset:8192
  ds_read_b64_tr_b16 v[74:75], v3 offset:9216
  ds_read_b64_tr_b16 v[76:77], v6 offset:8192
  ds_read_b64_tr_b16 v[78:79], v6 offset:9216
  s_waitcnt vmcnt(22)
  s_waitcnt lgkmcnt(4)
  v_mfma_f32_32x32x16_bf16 v[8:23], v[80:83], v[112:115], v[8:23]
  v_mfma_f32_32x32x16_bf16 v[24:39], v[84:87], v[112:115], v[24:39]
  v_mfma_f32_32x32x16_bf16 v[40:55], v[80:83], v[116:119], v[40:55]
  v_mfma_f32_32x32x16_bf16 v[56:71], v[84:87], v[116:119], v[56:71]
  buffer_load_dwordx4 v[112:115], v1, s[40:43], s64 offen offset:0 sc1
  buffer_load_dwordx4 v[116:119], v1, s[40:43], s65 offen offset:0 sc1
  s_add_u32 m0, s15, 6144
  s_add_u32 s14, s63, 0
  buffer_load_dwordx4 v2, s[48:51], s14 offen lds
  s_add_u32 m0, s15, 7168
  s_add_u32 s14, s63, 7168
  buffer_load_dwordx4 v2, s[48:51], s14 offen lds
  s_waitcnt vmcnt(20)
  ds_read_b64_tr_b16 v[80:81], v3 offset:10240
  ds_read_b64_tr_b16 v[82:83], v3 offset:11264
  ds_read_b64_tr_b16 v[84:85], v6 offset:10240
  ds_read_b64_tr_b16 v[86:87], v6 offset:11264
  s_waitcnt lgkmcnt(4)
  v_mfma_f32_32x32x16_bf16 v[8:23], v[72:75], v[120:123], v[8:23]
  v_mfma_f32_32x32x16_bf16 v[24:39], v[76:79], v[120:123], v[24:39]
  v_mfma_f32_32x32x16_bf16 v[40:55], v[72:75], v[124:127], v[40:55]
  v_mfma_f32_32x32x16_bf16 v[56:71], v[76:79], v[124:127], v[56:71]
  buffer_load_dwordx4 v[120:123], v1, s[40:43], s64 offen offset:1024 sc1
  buffer_load_dwordx4 v[124:127], v1, s[40:43], s65 offen offset:1024 sc1
  s_add_u32 m0, s15, 8192
  s_add_u32 s14, s63, 14336
  buffer_load_dwordx4 v2, s[48:51], s14 offen lds
  s_add_u32 m0, s15, 9216
  s_add_u32 s14, s63, 21504
  buffer_load_dwordx4 v2, s[48:51], s14 offen lds
  s_waitcnt vmcnt(20)
  ds_read_b64_tr_b16 v[72:73], v3 offset:12288
  ds_read_b64_tr_b16 v[74:75], v3 offset:13312
  ds_read_b64_tr_b16 v[76:77], v6 offset:12288
  ds_read_b64_tr_b16 v[78:79], v6 offset:13312
  s_waitcnt lgkmcnt(4)
  v_mfma_f32_32x32x16_bf16 v[8:23], v[80:83], v[128:131], v[8:23]
  v_mfma_f32_32x32x16_bf16 v[24:39], v[84:87], v[128:131], v[24:39]
  v_mfma_f32_32x32x16_bf16 v[40:55], v[80:83], v[132:135], v[40:55]
  v_mfma_f32_32x32x16_bf16 v[56:71], v[84:87], v[132:135], v[56:71]
  buffer_load_dwordx4 v[128:131], v1, s[40:43], s64 offen offset:2048 sc1
  buffer_load_dwordx4 v[132:135], v1, s[40:43], s65 offen offset:2048 sc1
  s_add_u32 m0, s15, 10240
  s_add_u32 s14, s63, 28672
  buffer_load_dwordx4 v2, s[48:51], s14 offen lds
  s_add_u32 m0, s15, 11264
  s_add_u32 s14, s63, 35840
  buffer_load_dwordx4 v2, s[48:51], s14 offen lds
  s_waitcnt vmcnt(20)
  ds_read_b64_tr_b16 v[80:81], v3 offset:0
  ds_read_b64_tr_b16 v[82:83], v3 offset:1024
  ds_read_b64_tr_b16 v[84:85], v6 offset:0
  ds_read_b64_tr_b16 v[86:87], v6 offset:1024
  s_waitcnt lgkmcnt(4)
  v_mfma_f32_32x32x16_bf16 v[8:23], v[72:75], v[136:139], v[8:23]
  v_mfma_f32_32x32x16_bf16 v[24:39], v[76:79], v[136:139], v[24:39]
  v_mfma_f32_32x32x16_bf16 v[40:55], v[72:75], v[140:143], v[40:55]
  v_mfma_f32_32x32x16_bf16 v[56:71], v[76:79], v[140:143], v[56:71]
  buffer_load_dwordx4 v[136:139], v1, s[40:43], s64 offen offset:3072 sc1
  buffer_load_dwordx4 v[140:143], v1, s[40:43], s65 offen offset:3072 sc1
  s_add_u32 m0, s15, 12288
  s_add_u32 s14, s63, 43008
  buffer_load_dwordx4 v2, s[48:51], s14 offen lds
  s_add_u32 m0, s15, 13312
  s_add_u32 s14, s63, 50176
  buffer_load_dwordx4 v2, s[48:51], s14 offen lds
  s_waitcnt vmcnt(20)
  ds_read_b64_tr_b16 v[72:73], v3 offset:2048
  ds_read_b64_tr_b16 v[74:75], v3 offset:3072
  ds_read_b64_tr_b16 v[76:77], v6 offset:2048
  ds_read_b64_tr_b16 v[78:79], v6 offset:3072
  s_waitcnt lgkmcnt(4)
  v_mfma_f32_32x32x16_bf16 v[8:23], v[80:83], v[88:91], v[8:23]
  v_mfma_f32_32x32x16_bf16 v[24:39], v[84:87], v[88:91], v[24:39]
  v_mfma_f32_32x32x16_bf16 v[40:55], v[80:83], v[92:95], v[40:55]
  v_mfma_f32_32x32x16_bf16 v[56:71], v[84:87], v[92:95], v[56:71]
  s_add_u32 m0, s15, 0
  s_add_u32 s14, s67, 0
  buffer_load_dwordx4 v2, s[52:55], s14 offen lds
  s_add_u32 m0, s15, 1024
  s_add_u32 s14, s67, 7168
  buffer_load_dwordx4 v2, s[52:55], s14 offen lds
  s_waitcnt vmcnt(18)
  ds_read_b64_tr_b16 v[80:81], v3 offset:4096
  ds_read_b64_tr_b16 v[82:83], v3 offset:5120
  ds_read_b64_tr_b16 v[84:85], v6 offset:4096
  ds_read_b64_tr_b16 v[86:87], v6 offset:5120
  s_waitcnt lgkmcnt(4)
  v_mfma_f32_32x32x16_bf16 v[8:23], v[72:75], v[96:99], v[8:23]
  v_mfma_f32_32x32x16_bf16 v[24:39], v[76:79], v[96:99], v[24:39]
  v_mfma_f32_32x32x16_bf16 v[40:55], v[72:75], v[100:103], v[40:55]
  v_mfma_f32_32x32x16_bf16 v[56:71], v[76:79], v[100:103], v[56:71]
  s_add_u32 m0, s15, 2048
  s_add_u32 s14, s67, 14336
  buffer_load_dwordx4 v2, s[52:55], s14 offen lds
  s_add_u32 m0, s15, 3072
  s_add_u32 s14, s67, 21504
  buffer_load_dwordx4 v2, s[52:55], s14 offen lds
  s_waitcnt vmcnt(16)
  ds_read_b64_tr_b16 v[72:73], v3 offset:6144
  ds_read_b64_tr_b16 v[74:75], v3 offset:7168
  ds_read_b64_tr_b16 v[76:77], v6 offset:6144
  ds_read_b64_tr_b16 v[78:79], v6 offset:7168
  s_waitcnt lgkmcnt(4)
  v_mfma_f32_32x32x16_bf16 v[8:23], v[80:83], v[104:107], v[8:23]
  v_mfma_f32_32x32x16_bf16 v[24:39], v[84:87], v[104:107], v[24:39]
  v_mfma_f32_32x32x16_bf16 v[40:55], v[80:83], v[108:111], v[40:55]
  v_mfma_f32_32x32x16_bf16 v[56:71], v[84:87], v[108:111], v[56:71]
  s_add_u32 m0, s15, 4096
  s_add_u32 s14, s67, 28672
  buffer_load_dwordx4 v2, s[52:55], s14 offen lds
  s_add_u32 m0, s15, 5120
  s_add_u32 s14, s67, 35840
  buffer_load_dwordx4 v2, s[52:55], s14 offen lds
  s_waitcnt vmcnt(14)
  ds_read_b64_tr_b16 v[80:81], v3 offset:8192
  ds_read_b64_tr_b16 v[82:83], v3 offset:9216
  ds_read_b64_tr_b16 v[84:85], v6 offset:8192
  ds_read_b64_tr_b16 v[86:87], v6 offset:9216
  s_waitcnt lgkmcnt(4)
  v_mfma_f32_32x32x16_bf16 v[8:23], v[72:75], v[112:115], v[8:23]
  v_mfma_f32_32x32x16_bf16 v[24:39], v[76:79], v[112:115], v[24:39]
  v_mfma_f32_32x32x16_bf16 v[40:55], v[72:75], v[116:119], v[40:55]
  v_mfma_f32_32x32x16_bf16 v[56:71], v[76:79], v[116:119], v[56:71]
  s_add_u32 m0, s15, 6144
  s_add_u32 s14, s67, 43008
  buffer_load_dwordx4 v2, s[52:55], s14 offen lds
  s_add_u32 m0, s15, 7168
  s_add_u32 s14, s67, 50176
  buffer_load_dwordx4 v2, s[52:55], s14 offen lds
  s_waitcnt vmcnt(12)
  ds_read_b64_tr_b16 v[72:73], v3 offset:10240
  ds_read_b64_tr_b16 v[74:75], v3 offset:11264
  ds_read_b64_tr_b16 v[76:77], v6 offset:10240
  ds_read_b64_tr_b16 v[78:79], v6 offset:11264
  s_waitcnt lgkmcnt(4)
  v_mfma_f32_32x32x16_bf16 v[8:23], v[80:83], v[120:123], v[8:23]
  v_mfma_f32_32x32x16_bf16 v[24:39], v[84:87], v[120:123], v[24:39]
  v_mfma_f32_32x32x16_bf16 v[40:55], v[80:83], v[124:127], v[40:55]
  v_mfma_f32_32x32x16_bf16 v[56:71], v[84:87], v[124:127], v[56:71]
  s_add_u32 m0, s15, 8192
  s_add_u32 s14, s67, 57344
  buffer_load_dwordx4 v2, s[52:55], s14 offen lds
  s_add_u32 m0, s15, 9216
  s_add_u32 s14, s67, 64512
  buffer_load_dwordx4 v2, s[52:55], s14 offen lds
  s_waitcnt vmcnt(10)
  ds_read_b64_tr_b16 v[80:81], v3 offset:12288
  ds_read_b64_tr_b16 v[82:83], v3 offset:13312
  ds_read_b64_tr_b16 v[84:85], v6 offset:12288
  ds_read_b64_tr_b16 v[86:87], v6 offset:13312
  s_waitcnt lgkmcnt(4)
  v_mfma_f32_32x32x16_bf16 v[8:23], v[72:75], v[128:131], v[8:23]
  v_mfma_f32_32x32x16_bf16 v[24:39], v[76:79], v[128:131], v[24:39]
  v_mfma_f32_32x32x16_bf16 v[40:55], v[72:75], v[132:135], v[40:55]
  v_mfma_f32_32x32x16_bf16 v[56:71], v[76:79], v[132:135], v[56:71]
  s_add_u32 m0, s15, 10240
  s_add_u32 s14, s67, 71680
  buffer_load_dwordx4 v2, s[52:55], s14 offen lds
  s_add_u32 m0, s15, 11264
  s_add_u32 s14, s67, 78848
  buffer_load_dwordx4 v2, s[52:55], s14 offen lds
  s_waitcnt lgkmcnt(0)
  v_mfma_f32_32x32x16_bf16 v[8:23], v[80:83], v[136:139], v[8:23]
  v_mfma_f32_32x32x16_bf16 v[24:39], v[84:87], v[136:139], v[24:39]
  v_mfma_f32_32x32x16_bf16 v[40:55], v[80:83], v[140:143], v[40:55]
  v_mfma_f32_32x32x16_bf16 v[56:71], v[84:87], v[140:143], v[56:71]
  s_add_u32 m0, s15, 12288
  s_add_u32 s14, s67, 86016
  buffer_load_dwordx4 v2, s[52:55], s14 offen lds
  s_add_u32 m0, s15, 13312
  s_add_u32 s14, s67, 93184
  buffer_load_dwordx4 v2, s[52:55], s14 offen lds
  v_mov_b32 v73, 113664
  v_mov_b32 v74, 1
  s_lshl_b32 s3, s4, 2
  v_mov_b32 v75, s3
  v_add_u32 v75, 113888, v75
  v_xor_b32 v76, 8, v75
  v_xor_b32 v77, 4, v75
  s_and_b32 s3, s4, 1
  s_lshl_b32 s3, s3, 13
  s_cmp_lt_u32 s4, 2
  s_cselect_b32 s14, 0, 16384
  s_add_u32 s3, s3, s14
  s_add_u32 s3, s3, 65536
  v_add_u32 v7, s3, v1
  v_xor_b32 v2, 16384, v7
  s_mov_b32 s71, 32768
L_g0:
  ds_read_b32 v72, v73 offset:48
  s_sub_u32 s71, s71, 1
  s_waitcnt lgkmcnt(0)
  v_cmp_ne_u32 vcc, 4, v72
  s_cmp_eq_u32 s71, 0
  s_cbranch_scc1 L_g0_x
  s_cmp_eq_u64 vcc, 0
  s_cbranch_scc1 L_g0_x
  s_sleep 1
  s_branch L_g0
L_g0_x:
  s_mov_b32 s71, 32768
L_g1:
  ds_read_b32 v72, v73 offset:176
  s_sub_u32 s71, s71, 1
  s_waitcnt lgkmcnt(0)
  v_cmp_ne_u32 vcc, 4, v72
  s_cmp_eq_u32 s71, 0
  s_cbranch_scc1 L_g1_x
  s_cmp_eq_u64 vcc, 0
  s_cbranch_scc1 L_g1_x
  s_sleep 1
  s_branch L_g1
L_g1_x:
  ds_write_b128 v7, v[40:43] offset:0
  ds_write_b128 v7, v[44:47] offset:1024
  ds_write_b128 v7, v[48:51] offset:2048
  ds_write_b128 v7, v[52:55] offset:3072
  ds_write_b128 v7, v[56:59] offset:4096
  ds_write_b128 v7, v[60:63] offset:5120
  ds_write_b128 v7, v[64:67] offset:6144
  ds_write_b128 v7, v[68:71] offset:7168
  s_waitcnt lgkmcnt(0)
  ds_write_b32 v75, v74
  s_mov_b32 s71, 32768
L_h1:
  ds_read_b32 v72, v76
  s_sub_u32 s71, s71, 1
  s_waitcnt lgkmcnt(0)
  v_cmp_ne_u32 vcc, 1, v72
  s_cmp_eq_u32 s71, 0
  s_cbranch_scc1 L_h1_x
  s_cmp_eq_u64 vcc, 0
  s_cbranch_scc1 L_h1_x
  s_sleep 1
  s_branch L_h1
L_h1_x:
  ds_read_b128 v[56:59], v2 offset:4096
  ds_read_b128 v[60:63], v2 offset:5120
  ds_read_b128 v[64:67], v2 offset:6144
  ds_read_b128 v[68:71], v2 offset:7168
  ds_read_b128 v[40:43], v2 offset:0
  ds_read_b128 v[44:47], v2 offset:1024
  ds_read_b128 v[48:51], v2 offset:2048
  ds_read_b128 v[52:55], v2 offset:3072
  s_waitcnt lgkmcnt(4)
  v_add_f32 v24, v24, v56
  v_add_f32 v25, v25, v57
  v_add_f32 v26, v26, v58
  v_add_f32 v27, v27, v59
  v_add_f32 v28, v28, v60
  v_add_f32 v29, v29, v61
  v_add_f32 v30, v30, v62
  v_add_f32 v31, v31, v63
  v_add_f32 v32, v32, v64
  v_add_f32 v33, v33, v65
  v_add_f32 v34, v34, v66
  v_add_f32 v35, v35, v67
  v_add_f32 v36, v36, v68
  v_add_f32 v37, v37, v69
  v_add_f32 v38, v38, v70
  v_add_f32 v39, v39, v71
  s_waitcnt lgkmcnt(0)
  ds_write_b128 v2, v[24:27] offset:0
  ds_write_b128 v2, v[28:31] offset:1024
  ds_write_b128 v2, v[32:35] offset:2048
  ds_write_b128 v2, v[36:39] offset:3072
  v_add_f32 v8, v8, v40
  v_add_f32 v9, v9, v41
  v_add_f32 v10, v10, v42
  v_add_f32 v11, v11, v43
  v_add_f32 v12, v12, v44
  v_add_f32 v13, v13, v45
  v_add_f32 v14, v14, v46
  v_add_f32 v15, v15, v47
  v_add_f32 v16, v16, v48
  v_add_f32 v17, v17, v49
  v_add_f32 v18, v18, v50
  v_add_f32 v19, v19, v51
  v_add_f32 v20, v20, v52
  v_add_f32 v21, v21, v53
  v_add_f32 v22, v22, v54
  v_add_f32 v23, v23, v55
  v_xor_b32 v7, 8192, v7
  s_waitcnt lgkmcnt(0)
  ds_write_b32 v75, v74 offset:16
  s_mov_b32 s71, 32768
L_h2:
  ds_read_b32 v72, v77 offset:16
  s_sub_u32 s71, s71, 1
  s_waitcnt lgkmcnt(0)
  v_cmp_ne_u32 vcc, 1, v72
  s_cmp_eq_u32 s71, 0
  s_cbranch_scc1 L_h2_x
  s_cmp_eq_u64 vcc, 0
  s_cbranch_scc1 L_h2_x
  s_sleep 1
  s_branch L_h2
L_h2_x:
  v_xor_b32 v7, 16384, v7
  ds_read_b128 v[24:27], v7 offset:0
  ds_read_b128 v[28:31], v7 offset:1024
  ds_read_b128 v[32:35], v7 offset:2048
  ds_read_b128 v[36:39], v7 offset:3072
  s_waitcnt lgkmcnt(3)
  v_add_f32 v8, v8, v24
  v_add_f32 v9, v9, v25
  v_add_f32 v10, v10, v26
  v_add_f32 v11, v11, v27
  s_waitcnt lgkmcnt(2)
  v_add_f32 v12, v12, v28
  v_add_f32 v13, v13, v29
  v_add_f32 v14, v14, v30
  v_add_f32 v15, v15, v31
  s_waitcnt lgkmcnt(1)
  v_add_f32 v16, v16, v32
  v_add_f32 v17, v17, v33
  v_add_f32 v18, v18, v34
  v_add_f32 v19, v19, v35
  s_waitcnt lgkmcnt(0)
  v_add_f32 v20, v20, v36
  v_add_f32 v21, v21, v37
  v_add_f32 v22, v22, v38
  v_add_f32 v23, v23, v39
  s_mov_b32 s3, 0xbfb8aa3b
  v_mul_f32 v24, s3, v8
  v_mul_f32 v25, s3, v9
  v_mul_f32 v26, s3, v10
  v_mul_f32 v27, s3, v11
  v_mul_f32 v28, s3, v12
  v_mul_f32 v29, s3, v13
  v_mul_f32 v30, s3, v14
  v_mul_f32 v31, s3, v15
  v_mul_f32 v32, s3, v16
  v_mul_f32 v33, s3, v17
  v_mul_f32 v34, s3, v18
  v_mul_f32 v35, s3, v19
  v_mul_f32 v36, s3, v20
  v_mul_f32 v37, s3, v21
  v_mul_f32 v38, s3, v22
  v_mul_f32 v39, s3, v23
  v_exp_f32 v24, v24
  v_exp_f32 v25, v25
  v_exp_f32 v26, v26
  v_exp_f32 v27, v27
  v_exp_f32 v28, v28
  v_exp_f32 v29, v29
  v_exp_f32 v30, v30
  v_exp_f32 v31, v31
  v_exp_f32 v32, v32
  v_exp_f32 v33, v33
  v_exp_f32 v34, v34
  v_exp_f32 v35, v35
  v_exp_f32 v36, v36
  v_exp_f32 v37, v37
  v_exp_f32 v38, v38
  v_exp_f32 v39, v39
  v_add_f32 v24, 1.0, v24
  v_add_f32 v25, 1.0, v25
  v_add_f32 v26, 1.0, v26
  v_add_f32 v27, 1.0, v27
  v_add_f32 v28, 1.0, v28
  v_add_f32 v29, 1.0, v29
  v_add_f32 v30, 1.0, v30
  v_add_f32 v31, 1.0, v31
  v_add_f32 v32, 1.0, v32
  v_add_f32 v33, 1.0, v33
  v_add_f32 v34, 1.0, v34
  v_add_f32 v35, 1.0, v35
  v_add_f32 v36, 1.0, v36
  v_add_f32 v37, 1.0, v37
  v_add_f32 v38, 1.0, v38
  v_add_f32 v39, 1.0, v39
  v_rcp_f32 v24, v24
  v_rcp_f32 v25, v25
  v_rcp_f32 v26, v26
  v_rcp_f32 v27, v27
  v_rcp_f32 v28, v28
  v_rcp_f32 v29, v29
  v_rcp_f32 v30, v30
  v_rcp_f32 v31, v31
  v_rcp_f32 v32, v32
  v_rcp_f32 v33, v33
  v_rcp_f32 v34, v34
  v_rcp_f32 v35, v35
  v_rcp_f32 v36, v36
  v_rcp_f32 v37, v37
  v_rcp_f32 v38, v38
  v_rcp_f32 v39, v39
  v_mul_f32 v144, v8, v24
  v_mul_f32 v145, v9, v25
  v_mul_f32 v146, v10, v26
  v_mul_f32 v147, v11, v27
  v_mul_f32 v148, v12, v28
  v_mul_f32 v149, v13, v29
  v_mul_f32 v150, v14, v30
  v_mul_f32 v151, v15, v31
  v_mul_f32 v152, v16, v32
  v_mul_f32 v153, v17, v33
  v_mul_f32 v154, v18, v34
  v_mul_f32 v155, v19, v35
  v_mul_f32 v156, v20, v36
  v_mul_f32 v157, v21, v37
  v_mul_f32 v158, v22, v38
  v_mul_f32 v159, v23, v39
  v_bfe_u32 v76, v1, 4, 2
  v_lshlrev_b32 v7, 7, v76
  v_bfe_u32 v72, v1, 6, 1
  v_lshl_add_u32 v7, v72, 11, v7
  s_lshl_b32 s14, s9, 12
  s_lshl_b32 s3, s4, 9
  s_add_u32 s14, s14, s3
  s_add_u32 s14, s14, 17956864
  s_mov_b32 s71, 4096
  s_lshl_b32 s3, s4, 13
  s_add_u32 s3, s3, 13631488
  s_lshl_b32 s60, s57, 15
  s_add_u32 s60, s60, s3
  s_lshl_b32 s61, s58, 15
  s_add_u32 s61, s61, s3
  s_add_u32 s62, s60, 4096
  s_add_u32 s63, s61, 4096
  v_lshlrev_b32 v76, 3, v76
  v_add_u32 v76, 113728, v76
  s_setprio 0
L_op:
  buffer_load_dwordx2 v[72:73], v7, s[40:43], s14 offen sc1
  s_sub_u32 s71, s71, 1
  s_waitcnt vmcnt(0)
  v_cmp_eq_u64 vcc, v[72:73], v[4:5]
  s_cmp_eq_u32 s71, 0
  s_cbranch_scc1 L_op_x
  s_cmp_eq_u64 vcc, -1
  s_cbranch_scc1 L_op_x
  ds_read_b32 v74, v76
  s_waitcnt lgkmcnt(0)
  v_cmp_eq_u32 vcc, 2, v74
  s_nop 0
  s_cmp_eq_u64 vcc, -1
  s_cbranch_scc1 L_op
  s_sleep 2
  s_branch L_op
L_op_x:
  buffer_load_dwordx4 v[88:91], v1, s[40:43], s60 offen offset:0 sc1
  buffer_load_dwordx4 v[92:95], v1, s[40:43], s61 offen offset:0 sc1
  buffer_load_dwordx4 v[96:99], v1, s[40:43], s60 offen offset:1024 sc1
  buffer_load_dwordx4 v[100:103], v1, s[40:43], s61 offen offset:1024 sc1
  buffer_load_dwordx4 v[104:107], v1, s[40:43], s60 offen offset:2048 sc1
  buffer_load_dwordx4 v[108:111], v1, s[40:43], s61 offen offset:2048 sc1
  buffer_load_dwordx4 v[112:115], v1, s[40:43], s60 offen offset:3072 sc1
  buffer_load_dwordx4 v[116:119], v1, s[40:43], s61 offen offset:3072 sc1
  buffer_load_dwordx4 v[120:123], v1, s[40:43], s62 offen offset:0 sc1
  buffer_load_dwordx4 v[124:127], v1, s[40:43], s63 offen offset:0 sc1
  buffer_load_dwordx4 v[128:131], v1, s[40:43], s62 offen offset:1024 sc1
  buffer_load_dwordx4 v[132:135], v1, s[40:43], s63 offen offset:1024 sc1
  buffer_load_dwordx4 v[136:139], v1, s[40:43], s62 offen offset:2048 sc1
  buffer_load_dwordx4 v[140:143], v1, s[40:43], s63 offen offset:2048 sc1
  ds_read_b64_tr_b16 v[72:73], v3 offset:0
  ds_read_b64_tr_b16 v[74:75], v3 offset:1024
  ds_read_b64_tr_b16 v[76:77], v6 offset:0
  ds_read_b64_tr_b16 v[78:79], v6 offset:1024
  ds_read_b64_tr_b16 v[80:81], v3 offset:2048
  ds_read_b64_tr_b16 v[82:83], v3 offset:3072
  ds_read_b64_tr_b16 v[84:85], v6 offset:2048
  ds_read_b64_tr_b16 v[86:87], v6 offset:3072
  s_waitcnt lgkmcnt(4)
  s_waitcnt vmcnt(13)
  v_mfma_f32_32x32x16_bf16 v[8:23], v[72:75], v[88:91], 0
  v_mfma_f32_32x32x16_bf16 v[24:39], v[76:79], v[88:91], 0
  s_waitcnt vmcnt(12)
  v_mfma_f32_32x32x16_bf16 v[40:55], v[72:75], v[92:95], 0
  v_mfma_f32_32x32x16_bf16 v[56:71], v[76:79], v[92:95], 0
  buffer_load_dwordx4 v[88:91], v1, s[40:43], s62 offen offset:3072 sc1
  buffer_load_dwordx4 v[92:95], v1, s[40:43], s63 offen offset:3072 sc1
  ds_read_b64_tr_b16 v[72:73], v3 offset:3072
  ds_read_b64_tr_b16 v[74:75], v3 offset:4096
  ds_read_b64_tr_b16 v[76:77], v6 offset:3072
  ds_read_b64_tr_b16 v[78:79], v6 offset:4096
  s_waitcnt lgkmcnt(4)
  s_waitcnt vmcnt(13)
  v_mfma_f32_32x32x16_bf16 v[8:23], v[80:83], v[96:99], v[8:23]
  v_mfma_f32_32x32x16_bf16 v[24:39], v[84:87], v[96:99], v[24:39]
  s_waitcnt vmcnt(12)
  v_mfma_f32_32x32x16_bf16 v[40:55], v[80:83], v[100:103], v[40:55]
  v_mfma_f32_32x32x16_bf16 v[56:71], v[84:87], v[100:103], v[56:71]
  ds_read_b64_tr_b16 v[80:81], v3 offset:5120
  ds_read_b64_tr_b16 v[82:83], v3 offset:6144
  ds_read_b64_tr_b16 v[84:85], v6 offset:5120
  ds_read_b64_tr_b16 v[86:87], v6 offset:6144
  s_waitcnt lgkmcnt(4)
  s_waitcnt vmcnt(11)
  v_mfma_f32_32x32x16_bf16 v[8:23], v[72:75], v[104:107], v[8:23]
  v_mfma_f32_32x32x16_bf16 v[24:39], v[76:79], v[104:107], v[24:39]
  s_waitcnt vmcnt(10)
  v_mfma_f32_32x32x16_bf16 v[40:55], v[72:75], v[108:111], v[40:55]
  v_mfma_f32_32x32x16_bf16 v[56:71], v[76:79], v[108:111], v[56:71]
  ds_read_b64_tr_b16 v[72:73], v3 offset:7168
  ds_read_b64_tr_b16 v[74:75], v3 offset:8192
  ds_read_b64_tr_b16 v[76:77], v6 offset:7168
  ds_read_b64_tr_b16 v[78:79], v6 offset:8192
  s_waitcnt lgkmcnt(4)
  s_waitcnt vmcnt(9)
  v_mfma_f32_32x32x16_bf16 v[8:23], v[80:83], v[112:115], v[8:23]
  v_mfma_f32_32x32x16_bf16 v[24:39], v[84:87], v[112:115], v[24:39]
  s_waitcnt vmcnt(8)
  v_mfma_f32_32x32x16_bf16 v[40:55], v[80:83], v[116:119], v[40:55]
  v_mfma_f32_32x32x16_bf16 v[56:71], v[84:87], v[116:119], v[56:71]
  ds_read_b64_tr_b16 v[80:81], v3 offset:9216
  ds_read_b64_tr_b16 v[82:83], v3 offset:10240
  ds_read_b64_tr_b16 v[84:85], v6 offset:9216
  ds_read_b64_tr_b16 v[86:87], v6 offset:10240
  s_waitcnt lgkmcnt(4)
  s_waitcnt vmcnt(7)
  v_mfma_f32_32x32x16_bf16 v[8:23], v[72:75], v[120:123], v[8:23]
  v_mfma_f32_32x32x16_bf16 v[24:39], v[76:79], v[120:123], v[24:39]
  s_waitcnt vmcnt(6)
  v_mfma_f32_32x32x16_bf16 v[40:55], v[72:75], v[124:127], v[40:55]
  v_mfma_f32_32x32x16_bf16 v[56:71], v[76:79], v[124:127], v[56:71]
  ds_read_b64_tr_b16 v[72:73], v3 offset:10240
  ds_read_b64_tr_b16 v[74:75], v3 offset:11264
  ds_read_b64_tr_b16 v[76:77], v6 offset:10240
  ds_read_b64_tr_b16 v[78:79], v6 offset:11264
  s_waitcnt lgkmcnt(4)
  s_waitcnt vmcnt(5)
  v_mfma_f32_32x32x16_bf16 v[8:23], v[80:83], v[128:131], v[8:23]
  v_mfma_f32_32x32x16_bf16 v[24:39], v[84:87], v[128:131], v[24:39]
  s_waitcnt vmcnt(4)
  v_mfma_f32_32x32x16_bf16 v[40:55], v[80:83], v[132:135], v[40:55]
  v_mfma_f32_32x32x16_bf16 v[56:71], v[84:87], v[132:135], v[56:71]
  ds_read_b64_tr_b16 v[80:81], v3 offset:12288
  ds_read_b64_tr_b16 v[82:83], v3 offset:13312
  ds_read_b64_tr_b16 v[84:85], v6 offset:12288
  ds_read_b64_tr_b16 v[86:87], v6 offset:13312
  s_waitcnt lgkmcnt(4)
  s_waitcnt vmcnt(3)
  v_mfma_f32_32x32x16_bf16 v[8:23], v[72:75], v[136:139], v[8:23]
  v_mfma_f32_32x32x16_bf16 v[24:39], v[76:79], v[136:139], v[24:39]
  s_waitcnt vmcnt(2)
  v_mfma_f32_32x32x16_bf16 v[40:55], v[72:75], v[140:143], v[40:55]
  v_mfma_f32_32x32x16_bf16 v[56:71], v[76:79], v[140:143], v[56:71]
  s_waitcnt lgkmcnt(0)
  s_waitcnt vmcnt(1)
  v_mfma_f32_32x32x16_bf16 v[8:23], v[80:83], v[88:91], v[8:23]
  v_mfma_f32_32x32x16_bf16 v[24:39], v[84:87], v[88:91], v[24:39]
  s_waitcnt vmcnt(0)
  v_mfma_f32_32x32x16_bf16 v[40:55], v[80:83], v[92:95], v[40:55]
  v_mfma_f32_32x32x16_bf16 v[56:71], v[84:87], v[92:95], v[56:71]
  v_add_u32 v7, s15, v1
  s_nop 7
  ds_write_b128 v7, v[24:27] offset:0
  ds_write_b128 v7, v[28:31] offset:1024
  ds_write_b128 v7, v[32:35] offset:2048
  ds_write_b128 v7, v[36:39] offset:3072
  ds_write_b128 v7, v[40:43] offset:4096
  ds_write_b128 v7, v[44:47] offset:5120
  ds_write_b128 v7, v[48:51] offset:6144
  ds_write_b128 v7, v[52:55] offset:7168
  ds_write_b128 v7, v[56:59] offset:8192
  ds_write_b128 v7, v[60:63] offset:9216
  ds_write_b128 v7, v[64:67] offset:10240
  ds_write_b128 v7, v[68:71] offset:11264
  s_mov_b32 s44, s30
  s_mov_b32 s45, s31
  s_mov_b32 s46, 1835008
  s_mov_b32 s47, 0x20000
  v_lshlrev_b32 v88, 16, v160
  v_and_b32 v89, 0xffff0000, v160
  v_lshlrev_b32 v90, 16, v161
  v_and_b32 v91, 0xffff0000, v161
  v_lshlrev_b32 v92, 16, v162
  v_and_b32 v93, 0xffff0000, v162
  v_lshlrev_b32 v94, 16, v163
  v_and_b32 v95, 0xffff0000, v163
  v_lshlrev_b32 v96, 16, v164
  v_and_b32 v97, 0xffff0000, v164
  v_lshlrev_b32 v98, 16, v165
  v_and_b32 v99, 0xffff0000, v165
  v_lshlrev_b32 v100, 16, v166
  v_and_b32 v101, 0xffff0000, v166
  v_lshlrev_b32 v102, 16, v167
  v_and_b32 v103, 0xffff0000, v167
  v_mov_b32 v73, 113884
  v_mov_b32 v74, 1
  s_mov_b64 exec, 1
  s_waitcnt lgkmcnt(0)
  ds_add_u32 v73, v74
  s_mov_b64 exec, -1
  s_mov_b32 s71, 32768
L_ss0:
  ds_read_b32 v72, v73
  s_sub_u32 s71, s71, 1
  s_waitcnt lgkmcnt(0)
  v_cmp_ne_u32 vcc, 4, v72
  s_cmp_eq_u32 s71, 0
  s_cbranch_scc1 L_ss0_x
  s_cmp_eq_u64 vcc, 0
  s_cbranch_scc1 L_ss0_x
  s_sleep 1
  s_branch L_ss0
L_ss0_x:
  s_xor_b32 s3, s4, 1
  s_lshl_b32 s3, s3, 14
  s_add_u32 s3, s3, 98304
  v_add_u32 v7, s3, v1
  ds_read_b128 v[24:27], v7 offset:0
  ds_read_b128 v[28:31], v7 offset:1024
  ds_read_b128 v[32:35], v7 offset:2048
  ds_read_b128 v[36:39], v7 offset:3072
  s_xor_b32 s3, s4, 2
  s_lshl_b32 s3, s3, 14
  s_add_u32 s3, s3, 102400
  v_add_u32 v7, s3, v1
  ds_read_b128 v[40:43], v7 offset:0
  ds_read_b128 v[44:47], v7 offset:1024
  ds_read_b128 v[48:51], v7 offset:2048
  ds_read_b128 v[52:55], v7 offset:3072
  s_xor_b32 s3, s4, 3
  s_lshl_b32 s3, s3, 14
  s_add_u32 s3, s3, 106496
  v_add_u32 v7, s3, v1
  ds_read_b128 v[56:59], v7 offset:0
  ds_read_b128 v[60:63], v7 offset:1024
  ds_read_b128 v[64:67], v7 offset:2048
  ds_read_b128 v[68:71], v7 offset:3072
  s_waitcnt lgkmcnt(8)
  v_add_f32 v8, v8, v24
  v_add_f32 v9, v9, v25
  v_add_f32 v10, v10, v26
  v_add_f32 v11, v11, v27
  v_add_f32 v12, v12, v28
  v_add_f32 v13, v13, v29
  v_add_f32 v14, v14, v30
  v_add_f32 v15, v15, v31
  v_add_f32 v16, v16, v32
  v_add_f32 v17, v17, v33
  v_add_f32 v18, v18, v34
  v_add_f32 v19, v19, v35
  v_add_f32 v20, v20, v36
  v_add_f32 v21, v21, v37
  v_add_f32 v22, v22, v38
  v_add_f32 v23, v23, v39
  s_waitcnt lgkmcnt(4)
  v_add_f32 v8, v8, v40
  v_add_f32 v9, v9, v41
  v_add_f32 v10, v10, v42
  v_add_f32 v11, v11, v43
  v_add_f32 v12, v12, v44
  v_add_f32 v13, v13, v45
  v_add_f32 v14, v14, v46
  v_add_f32 v15, v15, v47
  v_add_f32 v16, v16, v48
  v_add_f32 v17, v17, v49
  v_add_f32 v18, v18, v50
  v_add_f32 v19, v19, v51
  v_add_f32 v20, v20, v52
  v_add_f32 v21, v21, v53
  v_add_f32 v22, v22, v54
  v_add_f32 v23, v23, v55
  s_waitcnt lgkmcnt(0)
  v_add_f32 v8, v8, v56
  v_add_f32 v9, v9, v57
  v_add_f32 v10, v10, v58
  v_add_f32 v11, v11, v59
  v_add_f32 v12, v12, v60
  v_add_f32 v13, v13, v61
  v_add_f32 v14, v14, v62
  v_add_f32 v15, v15, v63
  v_add_f32 v16, v16, v64
  v_add_f32 v17, v17, v65
  v_add_f32 v18, v18, v66
  v_add_f32 v19, v19, v67
  v_add_f32 v20, v20, v68
  v_add_f32 v21, v21, v69
  v_add_f32 v22, v22, v70
  v_add_f32 v23, v23, v71
  v_fma_f32 v8, v8, v144, v88
  v_fma_f32 v9, v9, v145, v89
  v_fma_f32 v10, v10, v146, v90
  v_fma_f32 v11, v11, v147, v91
  v_fma_f32 v12, v12, v148, v92
  v_fma_f32 v13, v13, v149, v93
  v_fma_f32 v14, v14, v150, v94
  v_fma_f32 v15, v15, v151, v95
  v_fma_f32 v16, v16, v152, v96
  v_fma_f32 v17, v17, v153, v97
  v_fma_f32 v18, v18, v154, v98
  v_fma_f32 v19, v19, v155, v99
  v_fma_f32 v20, v20, v156, v100
  v_fma_f32 v21, v21, v157, v101
  v_fma_f32 v22, v22, v158, v102
  v_fma_f32 v23, v23, v159, v103
  v_cvt_pk_bf16_f32 v72, v8, v9
  v_cvt_pk_bf16_f32 v73, v10, v11
  v_cvt_pk_bf16_f32 v74, v12, v13
  v_cvt_pk_bf16_f32 v75, v14, v15
  v_cvt_pk_bf16_f32 v76, v16, v17
  v_cvt_pk_bf16_f32 v77, v18, v19
  v_cvt_pk_bf16_f32 v78, v20, v21
  v_cvt_pk_bf16_f32 v79, v22, v23
  buffer_store_dwordx2 v[72:73], v0, s[44:47], 0 offen offset:0
  buffer_store_dwordx2 v[74:75], v0, s[44:47], 0 offen offset:16
  buffer_store_dwordx2 v[76:77], v0, s[44:47], 0 offen offset:32
  buffer_store_dwordx2 v[78:79], v0, s[44:47], 0 offen offset:48
L_s_end:
  s_endpgm
L_exit:
  s_endpgm
L_code_end:
.section .rodata,"a"
.p2align 6
.amdhsa_kernel recurrent_scan__mha_block__geglu_ffn__prompt_kernel
  .amdhsa_next_free_vgpr 168
  .amdhsa_next_free_sgpr 100
  .amdhsa_accum_offset 168
  .amdhsa_group_segment_fixed_size 0
  .amdhsa_kernarg_size 80
  .amdhsa_user_sgpr_count 2
  .amdhsa_user_sgpr_kernarg_segment_ptr 1
  .amdhsa_system_sgpr_workgroup_id_x 1
.end_amdhsa_kernel
```
